```python
import torch

def _softmax(x, axis=-1):
    return torch.softmax(x, dim=axis)
def _gelu(x):
    return torch.nn.functional.gelu(x, approximate="tanh")
def _silu(x):
    return torch.nn.functional.silu(x)
def _sigmoid(x):
    return torch.sigmoid(x)
def _layernorm(x, axis=-1, eps=1e-5):
    m = x.mean(dim=axis, keepdim=True)
    v = x.var(dim=axis, keepdim=True, unbiased=False)
    return (x - m) / torch.sqrt(v + eps)
def _scatter_add(tgt, idx, src, axis=0):
    return tgt.clone().index_add_(axis, idx, src)
def _segment_sum(src, seg, n):
    out = torch.zeros((n,) + src.shape[1:], dtype=src.dtype)
    return out.index_add_(0, seg, src)
def _pad(x, pw):
    flat = tuple(v for pair in reversed(pw) for v in pair)
    return torch.nn.functional.pad(x, flat)

kernel_name = 'parallel_sum__grouped_kv_mqa__mixer_token_mlp__prompt'

def setup_inputs():

    _w = (lambda a: (lambda t: t.to(torch.bfloat16) if t.is_floating_point() else t)(torch.as_tensor(a)))
    def _A_setup():
        B, S, D, H = 1, 2048, 448, 16
        Dh = D // H
        return {
            "x": _w((lambda *s: torch.randn(*s, dtype=torch.bfloat16) * 0.05)(B, S, D)),
            "wq": _w((lambda *s: torch.randn(*s, dtype=torch.bfloat16) * 0.05)(D, H * Dh)),
            "wk": _w((lambda *s: torch.randn(*s, dtype=torch.bfloat16) * 0.05)(D, Dh)),
            "wv": _w((lambda *s: torch.randn(*s, dtype=torch.bfloat16) * 0.05)(D, Dh)),
            "wo": _w((lambda *s: torch.randn(*s, dtype=torch.bfloat16) * 0.05)(H * Dh, D)),
        }
    _A_in = _A_setup()

    def _B_setup():
        B, S, D, F = 1, 2048, 448, 1792
        return {
            "x": _w((lambda *s: torch.randn(*s, dtype=torch.bfloat16) * 0.05)(B, S, D)),
            "w1": _w((lambda *s: torch.randn(*s, dtype=torch.bfloat16) * 0.8)(S, F) * (S ** -0.5)),
            "b1": _w((lambda *s: torch.randn(*s, dtype=torch.bfloat16) * 12.8)(F) * 0.02),
            "w2": _w((lambda *s: torch.randn(*s, dtype=torch.bfloat16) * 0.2)(F, S) * (F ** -0.5)),
            "b2": _w((lambda *s: torch.randn(*s, dtype=torch.bfloat16) * 1.6)(S) * 0.02),
        }
    _B_in = _B_setup()

    return {
        "A_x": _A_in["x"],
        "A_wq": _A_in["wq"],
        "A_wk": _A_in["wk"],
        "A_wv": _A_in["wv"],
        "A_wo": _A_in["wo"],
        "B_x": _B_in["x"],
        "B_w1": _B_in["w1"],
        "B_b1": _B_in["b1"],
        "B_w2": _B_in["w2"],
        "B_b2": _B_in["b2"],
    }

def reference(A_x, A_wq, A_wk, A_wv, A_wo, B_x, B_w1, B_b1, B_w2, B_b2):
    def _A_ref(x, wq, wk, wv, wo):
        B, S, D = x.shape
        H = 16
        Dh = D // H
        q = (lambda x, *d: x.permute(*d))((x @ wq).reshape(B, S, H, Dh), 0, 2, 1, 3)
        k = x @ wk
        v = x @ wv
        scores = torch.einsum("bhqd,bkd->bhqk", q, k) * (Dh ** -0.5)
        p = _softmax(scores, axis=-1)
        o = torch.einsum("bhqk,bkd->bhqd", p, v)
        return (lambda x, *d: x.permute(*d))(o, 0, 2, 1, 3).reshape(B, S, H * Dh) @ wo

    def _B_ref(x, w1, b1, w2, b2):
        B, S, D = x.shape
        h = _layernorm(x, axis=-1)
        u = torch.einsum("bsd,sf->bdf", h, w1) + b1
        u = _gelu(u)
        y = torch.einsum("bdf,fs->bds", u, w2) + b2
        return (lambda x, *d: x.permute(*d))(y, 0, 2, 1)

    x = A_x
    xn = _layernorm(x, axis=-1)
    return x + _A_ref(xn, A_wq, A_wk, A_wv, A_wo) + _B_ref(xn, B_w1, B_b1, B_w2, B_b2)
```

```asm
; @launch grid=(256,1,1) block=(512,1,1) lds=163840
.amdgcn_target "amdgcn-amd-amdhsa--gfx950"
.text
    .globl parallel_sum__grouped_kv_mqa__mixer_token_mlp__prompt_kernel
    .p2align 8
    .type parallel_sum__grouped_kv_mqa__mixer_token_mlp__prompt_kernel,@function
parallel_sum__grouped_kv_mqa__mixer_token_mlp__prompt_kernel:
    s_cmp_ge_u32 s2, 256
    s_cbranch_scc1 L_exit
    s_load_dwordx16 s[16:31], s[0:1], 0
    s_load_dwordx8 s[32:39], s[0:1], 64
    s_load_dwordx2 s[40:41], s[0:1], 96
    s_getpc_b64 s[12:13]
L_pc_here:
    v_and_b32 v1, 63, v0
    v_lshrrev_b32 v16, 6, v0
    s_lshr_b32 s5, s2, 3
    v_readfirstlane_b32 s3, v16
    s_lshl_b32 s14, s5, 10
    v_lshlrev_b32 v25, 1, v0
    v_and_b32 v25, 0x3fc, v25
    v_add_u32 v25, s14, v25
    v_min_u32 v25, L_code_end-L_pc_here-4, v25
    global_load_dword v30, v25, s[12:13]
    v_mov_b32 v20, 0
    v_lshlrev_b32 v24, 2, v1
    s_mov_b32 exec_hi, 0
    ds_write_b32 v24, v20 offset:8192
    s_mov_b64 exec, -1
    s_and_b32 s4, s2, 7
    s_lshr_b32 s6, s5, 2
    s_lshl_b32 s8, s4, 3
    s_add_u32 s6, s6, s8
    s_and_b32 s7, s5, 3
    s_and_b32 s92, s3, 3
    v_mov_b32 v21, 1
    v_lshlrev_b32 v23, 4, v1
    s_lshl_b32 s8, s6, 3
    s_add_u32 s8, s8, s3
    s_mul_i32 s8, s8, 3584
    s_mul_i32 s9, s3, 3648
    s_add_u32 m0, s9, 8704
    s_mov_b32 s46, 1835008
    s_mov_b32 s47, 0x20000
    s_mov_b32 exec_hi, 0x00ffffff
    s_waitcnt lgkmcnt(0)
    s_mov_b32 s44, s16
    s_and_b32 s45, s17, 0xffff
    buffer_load_dwordx4 v23, s[44:47], s8 offen lds
    s_add_u32 m0, m0, 912
    s_add_u32 s8, s8, 896
    buffer_load_dwordx4 v23, s[44:47], s8 offen lds
    s_add_u32 m0, m0, 912
    s_add_u32 s8, s8, 896
    buffer_load_dwordx4 v23, s[44:47], s8 offen lds
    s_add_u32 m0, m0, 912
    s_add_u32 s8, s8, 896
    buffer_load_dwordx4 v23, s[44:47], s8 offen lds
L_nox:
    s_mov_b64 exec, -1
    s_mov_b32 s26, 1
    s_barrier
    s_cmp_lt_u32 s3, 4
    s_cbranch_scc1 L_A
    s_setprio 2
    s_cmp_ge_u32 s7, 2
    s_cbranch_scc1 L_nokv
    s_cmp_eq_u32 s7, 0
    s_cselect_b64 s[8:9], s[20:21], s[22:23]
    s_mov_b32 s52, s8
    s_and_b32 s53, s9, 0xffff
    s_mov_b32 s54, 25088
    s_mov_b32 s55, 0x20000
    s_lshl_b32 s9, s92, 10
    s_add_u32 m0, s9, 138240
    s_nop 0
    buffer_load_dwordx4 v23, s[52:55], s9 offen lds
    s_add_u32 m0, m0, 4096
    s_add_u32 s9, s9, 4096
    buffer_load_dwordx4 v23, s[52:55], s9 offen lds
    s_add_u32 m0, m0, 4096
    s_add_u32 s9, s9, 4096
    buffer_load_dwordx4 v23, s[52:55], s9 offen lds
    s_add_u32 m0, m0, 4096
    s_add_u32 s9, s9, 4096
    buffer_load_dwordx4 v23, s[52:55], s9 offen lds
    s_add_u32 m0, m0, 4096
    s_add_u32 s9, s9, 4096
    buffer_load_dwordx4 v23, s[52:55], s9 offen lds
    s_add_u32 m0, m0, 4096
    s_add_u32 s9, s9, 4096
    buffer_load_dwordx4 v23, s[52:55], s9 offen lds
    s_mov_b32 m0, 162816
    s_mov_b32 s9, 24576
    s_mov_b32 exec_hi, 0
    buffer_load_dwordx4 v23, s[52:55], s9 offen lds
    s_mov_b64 exec, -1
L_nokv:
    s_lshl_b32 s14, s2, 3
    s_add_u32 s14, s14, L_table-L_pc_here
    s_load_dwordx2 s[88:89], s[12:13], s14
    s_mov_b32 s84, s40
    s_and_b32 s85, s41, 0xffff
    s_mov_b32 s86, 16777216
    s_mov_b32 s87, 0x20000
    s_mov_b32 s80, s38
    s_and_b32 s81, s39, 0xffff
    s_mov_b32 s82, 256
    s_mov_b32 s83, 0x20000
    s_mov_b32 s60, s28
    s_and_b32 s61, s29, 0xffff
    s_mov_b32 s62, 7340032
    s_mov_b32 s63, 0x20000
    s_mov_b32 s64, s30
    s_and_b32 s65, s31, 0xffff
    s_mov_b32 s66, 3584
    s_mov_b32 s67, 0x20000
    s_mov_b32 s68, s32
    s_and_b32 s69, s33, 0xffff
    s_mov_b32 s70, 7340032
    s_mov_b32 s71, 0x20000
    s_mov_b32 s72, s34
    s_and_b32 s73, s35, 0xffff
    s_mov_b32 s74, 4096
    s_mov_b32 s75, 0x20000
    s_mov_b32 s56, s24
    s_and_b32 s57, s25, 0xffff
    s_mov_b32 s58, 401408
    s_mov_b32 s59, 0x20000
    s_mov_b32 s76, s36
    s_and_b32 s77, s37, 0xffff
    s_mov_b32 s78, 1835008
    s_mov_b32 s79, 0x20000
    v_lshlrev_b32 v12, 7, v1
    s_lshl_b32 s8, s2, 10
    s_add_u32 s8, s8, 6291456
    s_cmp_eq_u32 s92, 0
    s_cselect_b32 s8, s8, 16777216
    s_mov_b64 exec, 0xff
    buffer_store_dword v20, v12, s[84:87], s8 offen sc1
    s_mov_b64 exec, -1
    v_and_b32 v16, 15, v1
    v_bfe_u32 v17, v1, 4, 1
    v_lshrrev_b32 v18, 5, v1
    s_cmp_ge_u32 s7, 2
    s_cbranch_scc1 L_hpub
    v_lshrrev_b32 v19, 4, v1
    s_and_b32 s8, s92, 1
    s_lshr_b32 s9, s92, 1
    v_lshrrev_b32 v24, 2, v16
    v_lshl_add_u32 v24, v19, 3, v24
    v_mul_u32_u24 v24, 56, v24
    v_and_b32 v25, 3, v16
    v_lshl_add_u32 v24, v25, 3, v24
    s_lshl_b32 s11, s8, 5
    s_add_u32 s11, s11, 138240
    v_add_u32 v24, s11, v24
    s_lshl_b32 s11, s9, 4
    v_add_u32 v25, s11, v16
    v_lshlrev_b32 v27, 2, v25
    v_add_u32 v27, 163328, v27
    s_lshl_b32 s11, s9, 6
    s_add_u32 s11, s11, 163328
    v_lshl_add_u32 v28, v19, 4, s11
    v_mul_u32_u24 v25, 912, v25
    v_lshl_add_u32 v25, v19, 4, v25
    s_cmp_eq_u32 s7, 0
    s_cselect_b32 s12, s8, s9
    s_cselect_b32 s11, s9, s8
    s_lshl_b32 s12, s12, 10
    s_lshl_b32 s11, s11, 8
    s_add_u32 s12, s12, s11
    s_lshl_b32 s11, s7, 11
    s_add_u32 s12, s12, s11
    s_lshl_b32 s11, s6, 12
    s_add_u32 s12, s12, s11
    v_lshlrev_b32 v26, 9, v17
    v_lshl_add_u32 v26, v16, 4, v26
    v_lshl_add_u32 v26, v18, 3, v26
    v_mov_b32 v44, 0x3f803f80
    v_mov_b32 v45, 0x3f803f80
    v_mov_b32 v46, 0x3f803f80
    v_mov_b32 v47, 0x3f803f80
    s_waitcnt vmcnt(8)
    s_mov_b64 exec, 1
    ds_add_u32 v20, v21 offset:8192
    s_mov_b64 exec, -1
    s_waitcnt vmcnt(1)
    s_mov_b64 exec, 1
    ds_add_u32 v20, v21 offset:8196
    s_mov_b64 exec, -1
    s_mov_b32 s14, 0
L_ls_1:
    ds_read_b32 v22, v20 offset:8196
    s_add_u32 s14, s14, 1
    s_waitcnt lgkmcnt(0)
    v_readfirstlane_b32 s13, v22
    s_cmp_gt_u32 s14, 1600000
    s_cbranch_scc1 L_lsd_2
    s_cmp_ge_u32 s13, 8
    s_cbranch_scc1 L_lsd_2
    s_branch L_ls_1
L_lsd_2:
    ds_read_b64_tr_b16 v[96:97], v24 offset:0
    ds_read_b64_tr_b16 v[98:99], v24 offset:224
    ds_read_b128 v[100:103], v25 offset:8704
    ds_read_b64_tr_b16 v[104:105], v24 offset:1792
    ds_read_b64_tr_b16 v[106:107], v24 offset:2016
    ds_read_b128 v[108:111], v25 offset:8768
    ds_read_b64_tr_b16 v[112:113], v24 offset:3584
    ds_read_b64_tr_b16 v[114:115], v24 offset:3808
    ds_read_b128 v[116:119], v25 offset:8832
    ds_read_b64_tr_b16 v[120:121], v24 offset:5376
    ds_read_b64_tr_b16 v[122:123], v24 offset:5600
    ds_read_b128 v[124:127], v25 offset:8896
    ds_read_b64_tr_b16 v[128:129], v24 offset:7168
    ds_read_b64_tr_b16 v[130:131], v24 offset:7392
    ds_read_b128 v[132:135], v25 offset:8960
    ds_read_b64_tr_b16 v[136:137], v24 offset:8960
    ds_read_b64_tr_b16 v[138:139], v24 offset:9184
    ds_read_b128 v[140:143], v25 offset:9024
    ds_read_b64_tr_b16 v[144:145], v24 offset:10752
    ds_read_b64_tr_b16 v[146:147], v24 offset:10976
    ds_read_b128 v[148:151], v25 offset:9088
    ds_read_b64_tr_b16 v[152:153], v24 offset:12544
    ds_read_b64_tr_b16 v[154:155], v24 offset:12768
    ds_read_b128 v[156:159], v25 offset:9152
    ds_read_b64_tr_b16 v[160:161], v24 offset:14336
    ds_read_b64_tr_b16 v[162:163], v24 offset:14560
    ds_read_b128 v[164:167], v25 offset:9216
    ds_read_b64_tr_b16 v[168:169], v24 offset:16128
    ds_read_b64_tr_b16 v[170:171], v24 offset:16352
    ds_read_b128 v[172:175], v25 offset:9280
    ds_read_b64_tr_b16 v[176:177], v24 offset:17920
    ds_read_b64_tr_b16 v[178:179], v24 offset:18144
    ds_read_b128 v[180:183], v25 offset:9344
    ds_read_b64_tr_b16 v[184:185], v24 offset:19712
    ds_read_b64_tr_b16 v[186:187], v24 offset:19936
    ds_read_b128 v[188:191], v25 offset:9408
    ds_read_b64_tr_b16 v[192:193], v24 offset:21504
    ds_read_b64_tr_b16 v[194:195], v24 offset:21728
    ds_read_b128 v[196:199], v25 offset:9472
    ds_read_b64_tr_b16 v[200:201], v24 offset:23296
    ds_read_b64_tr_b16 v[202:203], v24 offset:23520
    ds_read_b128 v[204:207], v25 offset:9536
    s_cmp_eq_u32 s7, 0
    s_cbranch_scc0 L_v
    s_waitcnt lgkmcnt(15)
    v_mfma_f32_16x16x32_bf16 v[32:35], v[96:99], v[100:103], 0
    v_mfma_f32_16x16x32_bf16 v[40:43], v[96:99], v[44:47], 0
    v_mfma_f32_16x16x32_bf16 v[32:35], v[104:107], v[108:111], v[32:35]
    v_mfma_f32_16x16x32_bf16 v[40:43], v[104:107], v[44:47], v[40:43]
    v_mfma_f32_16x16x32_bf16 v[32:35], v[112:115], v[116:119], v[32:35]
    v_mfma_f32_16x16x32_bf16 v[40:43], v[112:115], v[44:47], v[40:43]
    v_mfma_f32_16x16x32_bf16 v[32:35], v[120:123], v[124:127], v[32:35]
    v_mfma_f32_16x16x32_bf16 v[40:43], v[120:123], v[44:47], v[40:43]
    v_mfma_f32_16x16x32_bf16 v[32:35], v[128:131], v[132:135], v[32:35]
    v_mfma_f32_16x16x32_bf16 v[40:43], v[128:131], v[44:47], v[40:43]
    v_mfma_f32_16x16x32_bf16 v[32:35], v[136:139], v[140:143], v[32:35]
    v_mfma_f32_16x16x32_bf16 v[40:43], v[136:139], v[44:47], v[40:43]
    v_mfma_f32_16x16x32_bf16 v[32:35], v[144:147], v[148:151], v[32:35]
    v_mfma_f32_16x16x32_bf16 v[40:43], v[144:147], v[44:47], v[40:43]
    v_mfma_f32_16x16x32_bf16 v[32:35], v[152:155], v[156:159], v[32:35]
    v_mfma_f32_16x16x32_bf16 v[40:43], v[152:155], v[44:47], v[40:43]
    v_mfma_f32_16x16x32_bf16 v[32:35], v[160:163], v[164:167], v[32:35]
    v_mfma_f32_16x16x32_bf16 v[40:43], v[160:163], v[44:47], v[40:43]
    s_waitcnt lgkmcnt(12)
    v_mfma_f32_16x16x32_bf16 v[32:35], v[168:171], v[172:175], v[32:35]
    v_mfma_f32_16x16x32_bf16 v[40:43], v[168:171], v[44:47], v[40:43]
    s_waitcnt lgkmcnt(9)
    v_mfma_f32_16x16x32_bf16 v[32:35], v[176:179], v[180:183], v[32:35]
    v_mfma_f32_16x16x32_bf16 v[40:43], v[176:179], v[44:47], v[40:43]
    s_waitcnt lgkmcnt(6)
    v_mfma_f32_16x16x32_bf16 v[32:35], v[184:187], v[188:191], v[32:35]
    v_mfma_f32_16x16x32_bf16 v[40:43], v[184:187], v[44:47], v[40:43]
    s_waitcnt lgkmcnt(3)
    v_mfma_f32_16x16x32_bf16 v[32:35], v[192:195], v[196:199], v[32:35]
    v_mfma_f32_16x16x32_bf16 v[40:43], v[192:195], v[44:47], v[40:43]
    s_waitcnt lgkmcnt(0)
    v_mfma_f32_16x16x32_bf16 v[32:35], v[200:203], v[204:207], v[32:35]
    v_mfma_f32_16x16x32_bf16 v[40:43], v[200:203], v[44:47], v[40:43]
    s_mov_b32 s14, 0
L_ls_3:
    ds_read_b32 v22, v20 offset:8260
    s_add_u32 s14, s14, 1
    s_waitcnt lgkmcnt(0)
    v_readfirstlane_b32 s13, v22
    s_cmp_gt_u32 s14, 1600000
    s_cbranch_scc1 L_lsd_4
    s_cmp_ge_u32 s13, 4
    s_cbranch_scc1 L_lsd_4
    s_branch L_ls_3
L_lsd_4:
    ds_read_b32 v52, v27 offset:128
    ds_read_b32 v56, v27
    s_waitcnt lgkmcnt(1)
    v_fma_f32 v32, -v52, v40, v32
    v_fma_f32 v33, -v52, v41, v33
    v_fma_f32 v34, -v52, v42, v34
    v_fma_f32 v35, -v52, v43, v35
    s_cmp_eq_u32 s8, 1
    s_cselect_b32 s15, 0xffff0000, 0
    s_mov_b32 s14, 0
    s_waitcnt lgkmcnt(0)
    v_pk_mul_f32 v[32:33], v[32:33], v[56:57] op_sel_hi:[1,0]
    v_pk_mul_f32 v[34:35], v[34:35], v[56:57] op_sel_hi:[1,0]
    v_cvt_pk_bf16_f32 v36, v32, v33
    v_cvt_pk_bf16_f32 v37, v34, v35
    s_mov_b64 exec, s[14:15]
    v_mov_b32 v36, 0x3f803f80
    v_mov_b32 v37, 0x00003f80
    s_mov_b64 exec, -1
    s_branch L_kvst
L_v:
    s_waitcnt lgkmcnt(15)
    v_mfma_f32_16x16x32_bf16 v[32:35], v[100:103], v[96:99], 0
    v_mfma_f32_16x16x32_bf16 v[40:43], v[44:47], v[96:99], 0
    v_mfma_f32_16x16x32_bf16 v[32:35], v[108:111], v[104:107], v[32:35]
    v_mfma_f32_16x16x32_bf16 v[40:43], v[44:47], v[104:107], v[40:43]
    v_mfma_f32_16x16x32_bf16 v[32:35], v[116:119], v[112:115], v[32:35]
    v_mfma_f32_16x16x32_bf16 v[40:43], v[44:47], v[112:115], v[40:43]
    v_mfma_f32_16x16x32_bf16 v[32:35], v[124:127], v[120:123], v[32:35]
    v_mfma_f32_16x16x32_bf16 v[40:43], v[44:47], v[120:123], v[40:43]
    v_mfma_f32_16x16x32_bf16 v[32:35], v[132:135], v[128:131], v[32:35]
    v_mfma_f32_16x16x32_bf16 v[40:43], v[44:47], v[128:131], v[40:43]
    v_mfma_f32_16x16x32_bf16 v[32:35], v[140:143], v[136:139], v[32:35]
    v_mfma_f32_16x16x32_bf16 v[40:43], v[44:47], v[136:139], v[40:43]
    v_mfma_f32_16x16x32_bf16 v[32:35], v[148:151], v[144:147], v[32:35]
    v_mfma_f32_16x16x32_bf16 v[40:43], v[44:47], v[144:147], v[40:43]
    v_mfma_f32_16x16x32_bf16 v[32:35], v[156:159], v[152:155], v[32:35]
    v_mfma_f32_16x16x32_bf16 v[40:43], v[44:47], v[152:155], v[40:43]
    v_mfma_f32_16x16x32_bf16 v[32:35], v[164:167], v[160:163], v[32:35]
    v_mfma_f32_16x16x32_bf16 v[40:43], v[44:47], v[160:163], v[40:43]
    s_waitcnt lgkmcnt(12)
    v_mfma_f32_16x16x32_bf16 v[32:35], v[172:175], v[168:171], v[32:35]
    v_mfma_f32_16x16x32_bf16 v[40:43], v[44:47], v[168:171], v[40:43]
    s_waitcnt lgkmcnt(9)
    v_mfma_f32_16x16x32_bf16 v[32:35], v[180:183], v[176:179], v[32:35]
    v_mfma_f32_16x16x32_bf16 v[40:43], v[44:47], v[176:179], v[40:43]
    s_waitcnt lgkmcnt(6)
    v_mfma_f32_16x16x32_bf16 v[32:35], v[188:191], v[184:187], v[32:35]
    v_mfma_f32_16x16x32_bf16 v[40:43], v[44:47], v[184:187], v[40:43]
    s_waitcnt lgkmcnt(3)
    v_mfma_f32_16x16x32_bf16 v[32:35], v[196:199], v[192:195], v[32:35]
    v_mfma_f32_16x16x32_bf16 v[40:43], v[44:47], v[192:195], v[40:43]
    s_waitcnt lgkmcnt(0)
    v_mfma_f32_16x16x32_bf16 v[32:35], v[204:207], v[200:203], v[32:35]
    v_mfma_f32_16x16x32_bf16 v[40:43], v[44:47], v[200:203], v[40:43]
    s_mov_b32 s14, 0
L_ls_5:
    ds_read_b32 v22, v20 offset:8260
    s_add_u32 s14, s14, 1
    s_waitcnt lgkmcnt(0)
    v_readfirstlane_b32 s13, v22
    s_cmp_gt_u32 s14, 1600000
    s_cbranch_scc1 L_lsd_6
    s_cmp_ge_u32 s13, 4
    s_cbranch_scc1 L_lsd_6
    s_branch L_ls_5
L_lsd_6:
    ds_read_b128 v[52:55], v28 offset:128
    ds_read_b128 v[56:59], v28
    s_waitcnt lgkmcnt(1)
    v_fma_f32 v32, -v52, v40, v32
    v_fma_f32 v33, -v53, v41, v33
    v_fma_f32 v34, -v54, v42, v34
    v_fma_f32 v35, -v55, v43, v35
    s_cmp_eq_u32 s8, 1
    s_cselect_b32 s8, 0xe000e000, 0
    s_mov_b32 s9, s8
    s_cselect_b32 s14, 0x10001000, 0
    s_mov_b32 s15, s14
    s_waitcnt lgkmcnt(0)
    v_pk_mul_f32 v[32:33], v[32:33], v[56:57]
    v_pk_mul_f32 v[34:35], v[34:35], v[58:59]
    v_cvt_pk_bf16_f32 v36, v32, v33
    v_cvt_pk_bf16_f32 v37, v34, v35
    s_mov_b64 exec, s[8:9]
    v_mov_b32 v36, 0
    v_mov_b32 v37, 0
    s_mov_b64 exec, s[14:15]
    v_mov_b32 v36, 0x3f803f80
    v_mov_b32 v37, 0x3f803f80
    s_mov_b64 exec, -1
L_kvst:
    buffer_store_dwordx2 v[36:37], v26, s[84:87], s12 offen sc1
    s_branch L_pub2
L_hpub:
    v_lshrrev_b32 v12, 2, v16
    v_lshl_add_u32 v12, v18, 2, v12
    v_mul_u32_u24 v12, 912, v12
    v_and_b32 v13, 3, v16
    v_lshl_add_u32 v12, v13, 3, v12
    v_lshl_add_u32 v12, v17, 5, v12
    s_sub_u32 s9, s7, 2
    s_mul_i32 s8, s9, 14592
    s_lshl_b32 s11, s92, 6
    s_add_u32 s8, s8, s11
    s_add_u32 s8, s8, 8704
    v_add_u32 v12, s8, v12
    s_lshl_b32 s8, s9, 6
    s_add_u32 s8, s8, 163584
    v_lshl_add_u32 v13, v18, 4, s8
    s_lshl_b32 s8, s6, 1
    s_add_u32 s8, s8, s9
    s_lshl_b32 s9, s92, 7
    s_add_u32 s8, s8, s9
    s_lshl_b32 s8, s8, 10
    s_add_u32 s8, s8, 262144
    s_waitcnt vmcnt(1)
    s_mov_b64 exec, 1
    ds_add_u32 v20, v21 offset:8192
    s_mov_b64 exec, -1
    s_mov_b32 s14, 0
L_ls_7:
    ds_read_b32 v22, v20 offset:8192
    s_add_u32 s14, s14, 1
    s_waitcnt lgkmcnt(0)
    v_readfirstlane_b32 s13, v22
    s_cmp_gt_u32 s14, 1600000
    s_cbranch_scc1 L_lsd_8
    s_cmp_ge_u32 s13, 8
    s_cbranch_scc1 L_lsd_8
    s_branch L_ls_7
L_lsd_8:
    ds_read_b64_tr_b16 v[96:97], v12 offset:0
    ds_read_b64_tr_b16 v[98:99], v12 offset:7296
    ds_read_b64_tr_b16 v[100:101], v12 offset:256
    ds_read_b64_tr_b16 v[102:103], v12 offset:7552
    ds_read_b64_tr_b16 v[104:105], v12 offset:512
    ds_read_b64_tr_b16 v[106:107], v12 offset:7808
    ds_read_b64_tr_b16 v[108:109], v12 offset:768
    ds_read_b64_tr_b16 v[110:111], v12 offset:8064
    s_waitcnt lgkmcnt(6)
    v_lshlrev_b32 v112, 16, v96
    v_and_b32 v113, 0xffff0000, v96
    v_lshlrev_b32 v114, 16, v97
    v_and_b32 v115, 0xffff0000, v97
    v_lshlrev_b32 v116, 16, v98
    v_and_b32 v117, 0xffff0000, v98
    v_lshlrev_b32 v118, 16, v99
    v_and_b32 v119, 0xffff0000, v99
    s_waitcnt lgkmcnt(4)
    v_lshlrev_b32 v120, 16, v100
    v_and_b32 v121, 0xffff0000, v100
    v_lshlrev_b32 v122, 16, v101
    v_and_b32 v123, 0xffff0000, v101
    v_lshlrev_b32 v124, 16, v102
    v_and_b32 v125, 0xffff0000, v102
    v_lshlrev_b32 v126, 16, v103
    v_and_b32 v127, 0xffff0000, v103
    s_waitcnt lgkmcnt(2)
    v_lshlrev_b32 v128, 16, v104
    v_and_b32 v129, 0xffff0000, v104
    v_lshlrev_b32 v130, 16, v105
    v_and_b32 v131, 0xffff0000, v105
    v_lshlrev_b32 v132, 16, v106
    v_and_b32 v133, 0xffff0000, v106
    v_lshlrev_b32 v134, 16, v107
    v_and_b32 v135, 0xffff0000, v107
    s_waitcnt lgkmcnt(0)
    v_lshlrev_b32 v136, 16, v108
    v_and_b32 v137, 0xffff0000, v108
    v_lshlrev_b32 v138, 16, v109
    v_and_b32 v139, 0xffff0000, v109
    v_lshlrev_b32 v140, 16, v110
    v_and_b32 v141, 0xffff0000, v110
    v_lshlrev_b32 v142, 16, v111
    v_and_b32 v143, 0xffff0000, v111
    s_mov_b32 s14, 0
L_ls_9:
    ds_read_b32 v22, v20 offset:8260
    s_add_u32 s14, s14, 1
    s_waitcnt lgkmcnt(0)
    v_readfirstlane_b32 s13, v22
    s_cmp_gt_u32 s14, 1600000
    s_cbranch_scc1 L_lsd_10
    s_cmp_ge_u32 s13, 4
    s_cbranch_scc1 L_lsd_10
    s_branch L_ls_9
L_lsd_10:
    ds_read_b128 v[32:35], v13
    ds_read_b128 v[40:43], v13 offset:128
    ds_read_b128 v[36:39], v13 offset:32
    ds_read_b128 v[44:47], v13 offset:160
    s_waitcnt lgkmcnt(0)
    v_pk_fma_f32 v[112:113], v[112:113], v[32:33], v[40:41]
    v_pk_fma_f32 v[114:115], v[114:115], v[34:35], v[42:43]
    v_pk_fma_f32 v[116:117], v[116:117], v[36:37], v[44:45]
    v_pk_fma_f32 v[118:119], v[118:119], v[38:39], v[46:47]
    v_cvt_pk_bf16_f32 v96, v112, v113
    v_cvt_pk_bf16_f32 v97, v114, v115
    v_cvt_pk_bf16_f32 v98, v116, v117
    v_cvt_pk_bf16_f32 v99, v118, v119
    buffer_store_dwordx4 v[96:99], v23, s[84:87], s8 offen sc1
    s_add_u32 s8, s8, 524288
    v_pk_fma_f32 v[120:121], v[120:121], v[32:33], v[40:41]
    v_pk_fma_f32 v[122:123], v[122:123], v[34:35], v[42:43]
    v_pk_fma_f32 v[124:125], v[124:125], v[36:37], v[44:45]
    v_pk_fma_f32 v[126:127], v[126:127], v[38:39], v[46:47]
    v_cvt_pk_bf16_f32 v100, v120, v121
    v_cvt_pk_bf16_f32 v101, v122, v123
    v_cvt_pk_bf16_f32 v102, v124, v125
    v_cvt_pk_bf16_f32 v103, v126, v127
    buffer_store_dwordx4 v[100:103], v23, s[84:87], s8 offen sc1
    s_add_u32 s8, s8, 524288
    v_pk_fma_f32 v[128:129], v[128:129], v[32:33], v[40:41]
    v_pk_fma_f32 v[130:131], v[130:131], v[34:35], v[42:43]
    v_pk_fma_f32 v[132:133], v[132:133], v[36:37], v[44:45]
    v_pk_fma_f32 v[134:135], v[134:135], v[38:39], v[46:47]
    v_cvt_pk_bf16_f32 v104, v128, v129
    v_cvt_pk_bf16_f32 v105, v130, v131
    v_cvt_pk_bf16_f32 v106, v132, v133
    v_cvt_pk_bf16_f32 v107, v134, v135
    buffer_store_dwordx4 v[104:107], v23, s[84:87], s8 offen sc1
    s_add_u32 s8, s8, 524288
    s_cmp_ge_u32 s92, 2
    s_cbranch_scc1 L_pub2
    v_pk_fma_f32 v[136:137], v[136:137], v[32:33], v[40:41]
    v_pk_fma_f32 v[138:139], v[138:139], v[34:35], v[42:43]
    v_pk_fma_f32 v[140:141], v[140:141], v[36:37], v[44:45]
    v_pk_fma_f32 v[142:143], v[142:143], v[38:39], v[46:47]
    v_cvt_pk_bf16_f32 v108, v136, v137
    v_cvt_pk_bf16_f32 v109, v138, v139
    v_cvt_pk_bf16_f32 v110, v140, v141
    v_cvt_pk_bf16_f32 v111, v142, v143
    buffer_store_dwordx4 v[108:111], v23, s[84:87], s8 offen sc1
    s_add_u32 s8, s8, 524288
L_pub2:
    s_bfe_u32 s93, s88, 327680
    s_bfe_u32 s94, s88, 196613
    s_bfe_u32 s96, s88, 65544
    s_bfe_u32 s95, s88, 327689
    s_bfe_u32 s19, s88, 196622
    s_bfe_u32 s97, s88, 65553
    s_bfe_u32 s16, s88, 262162
    s_bfe_u32 s17, s88, 262166
    s_bfe_u32 s18, s88, 131098
    s_bfe_u32 s22, s89, 524288
    s_bfe_u32 s41, s89, 65544
    s_bfe_u32 s21, s89, 131081
    s_bfe_u32 s20, s89, 327691
    s_lshl_b32 s23, s93, 2
    s_add_u32 s23, s23, s94
    s_lshl_b32 s23, s23, 2
    s_lshl_b32 s40, s94, 2
    s_min_u32 s40, s40, 11
    s_mul_i32 s101, s92, 32768
    s_add_u32 s101, s101, 8704
    v_lshrrev_b32 v24, 2, v16
    v_lshl_add_u32 v24, v18, 2, v24
    v_lshlrev_b32 v24, 7, v24
    v_bfe_u32 v25, v16, 1, 1
    v_lshl_add_u32 v25, v17, 1, v25
    v_bfe_u32 v26, v16, 3, 1
    v_lshl_add_u32 v25, v26, 2, v25
    v_lshl_add_u32 v24, v25, 4, v24
    v_and_b32 v25, 1, v16
    v_lshl_add_u32 v24, v25, 3, v24
    v_add_u32 v24, s101, v24
    s_lshr_b32 s8, s92, 1
    s_and_b32 s9, s92, 1
    s_lshl_b32 s10, s8, 6
    v_xor_b32 v2, s10, v24
    v_xor_b32 v3, 64, v2
    s_lshl_b32 s10, s9, 6
    v_xor_b32 v4, s10, v24
    v_xor_b32 v5, 64, v4
    s_lshl_b32 s10, s8, 10
    v_add_u32 v6, s10, v23
    v_xor_b32 v7, 0x400, v6
    s_lshl_b32 s10, s9, 10
    v_add_u32 v8, s10, v23
    v_xor_b32 v9, 0x400, v8
    v_lshrrev_b32 v14, 3, v1
    v_and_b32 v15, 7, v1
    v_bfe_u32 v25, v1, 4, 1
    v_lshlrev_b32 v25, 2, v25
    v_xor_b32 v15, v15, v25
    v_lshlrev_b32 v15, 4, v15
    s_and_b32 s8, s7, 1
    s_lshl_b32 s8, s8, 7
    s_lshr_b32 s9, s7, 1
    s_lshl_b32 s9, s9, 6
    s_add_u32 s8, s8, s9
    s_waitcnt vmcnt(0) lgkmcnt(0)
    s_mov_b64 exec, 1
    ds_add_rtn_u32 v22, v20, v21 offset:8216
    s_waitcnt lgkmcnt(0)
    v_cmp_eq_u32 vcc, 3, v22
    s_mov_b64 exec, -1
    s_cbranch_vccz L_noarr
    s_mov_b32 s10, 1
    s_atomic_add s10, s[80:81], s8 glc
    v_lshlrev_b32 v24, 10, v1
    s_mov_b32 s9, 6291456
    s_waitcnt lgkmcnt(0)
    s_and_b32 s10, s10, 63
    s_cmp_lg_u32 s10, 63
    s_cbranch_scc1 L_arrd
    s_mov_b32 s10, 1
    s_atomic_add s10, s[80:81], 32 glc
    s_waitcnt lgkmcnt(0)
    s_and_b32 s10, s10, 3
    s_cmp_lg_u32 s10, 3
    s_cbranch_scc1 L_arrd
    buffer_store_dword v21, v24, s[84:87], s9 offen sc1
    s_add_u32 s9, s9, 0x10000
    buffer_store_dword v21, v24, s[84:87], s9 offen sc1
    s_add_u32 s9, s9, 0x10000
    buffer_store_dword v21, v24, s[84:87], s9 offen sc1
    s_add_u32 s9, s9, 0x10000
    buffer_store_dword v21, v24, s[84:87], s9 offen sc1
L_arrd:
    s_mov_b64 exec, 1
    ds_add_u32 v20, v21 offset:8216
L_noarr:
    s_mov_b64 exec, -1
    s_branch L_G2
L_A:
    v_mul_u32_u24 v24, 4682, v1
    v_lshrrev_b32 v24, 16, v24
    v_mul_u32_u24 v25, 14, v24
    v_sub_u32 v25, v1, v25
    v_mul_u32_u24 v24, 896, v24
    v_lshl_add_u32 v24, v25, 4, v24
    s_mov_b32 s48, s18
    s_and_b32 s49, s19, 0xffff
    s_mov_b32 s50, 401408
    s_mov_b32 s51, 0x20000
    s_mul_i32 s9, s7, 224
    s_mul_i32 s10, s92, 100352
    s_add_u32 s9, s9, s10
    s_and_b32 s15, s6, 7
    s_mul_i32 s15, s15, 7
    s_lshr_b32 s15, s15, 1
    s_mul_i32 s10, s15, 3584
    s_add_u32 s9, s9, s10
    s_mul_i32 s10, s92, 25088
    s_mul_i32 s11, s15, 896
    s_add_u32 s10, s10, s11
    s_add_u32 m0, s10, 37888
    s_mov_b32 exec_hi, 0x00ffffff
    s_mov_b32 s11, 6
L_wq0:
    buffer_load_dwordx4 v24, s[48:51], s9 offen lds
    s_add_u32 s15, s15, 1
    s_cmp_eq_u32 s15, 28
    s_cselect_b32 s10, -27, 1
    s_mul_i32 s10, s10, 896
    s_add_u32 m0, m0, s10
    s_lshl_b32 s10, s10, 2
    s_add_u32 s9, s9, s10
    s_sub_u32 s11, s11, 1
    s_waitcnt vmcnt(63)
    s_cmp_lg_u32 s11, 0
    s_cbranch_scc1 L_wq0
    s_mov_b64 exec, -1
    s_setprio 3
    v_lshrrev_b32 v17, 3, v1
    s_lshl_b32 s8, s92, 3
    v_add_u32 v17, s8, v17
    v_and_b32 v18, 7, v1
    v_mul_u32_u24 v19, 912, v17
    v_lshl_add_u32 v19, v18, 4, v19
    v_lshlrev_b32 v17, 2, v17
    v_add_u32 v17, 163328, v17
    v_mov_b32 v2, 0
    v_mov_b32 v3, 0
    v_mov_b32 v4, 0
    v_mov_b32 v5, 0
    v_lshlrev_b32 v6, 2, v1
    s_mov_b32 s8, 0x3f803f80
    s_waitcnt vmcnt(6)
    s_mov_b64 exec, 3
    ds_add_u32 v6, v21 offset:8192
    s_mov_b64 exec, -1
    s_mov_b32 s14, 0
L_ls_11:
    ds_read_b32 v22, v20 offset:8192
    s_add_u32 s14, s14, 1
    s_waitcnt lgkmcnt(0)
    v_readfirstlane_b32 s13, v22
    s_cmp_gt_u32 s14, 1600000
    s_cbranch_scc1 L_lsd_12
    s_cmp_ge_u32 s13, 8
    s_cbranch_scc1 L_lsd_12
    s_branch L_ls_11
L_lsd_12:
    ds_read_b128 v[32:35], v19 offset:8704
    ds_read_b128 v[36:39], v19 offset:8832
    ds_read_b128 v[40:43], v19 offset:8960
    ds_read_b128 v[44:47], v19 offset:9088
    ds_read_b128 v[48:51], v19 offset:9216
    ds_read_b128 v[52:55], v19 offset:9344
    ds_read_b128 v[56:59], v19 offset:9472
    s_waitcnt lgkmcnt(6)
    v_dot2_f32_bf16 v2, v32, s8, v2
    v_dot2_f32_bf16 v3, v32, v32, v3
    v_dot2_f32_bf16 v4, v33, s8, v4
    v_dot2_f32_bf16 v5, v33, v33, v5
    v_dot2_f32_bf16 v2, v34, s8, v2
    v_dot2_f32_bf16 v3, v34, v34, v3
    v_dot2_f32_bf16 v4, v35, s8, v4
    v_dot2_f32_bf16 v5, v35, v35, v5
    s_waitcnt lgkmcnt(5)
    v_dot2_f32_bf16 v2, v36, s8, v2
    v_dot2_f32_bf16 v3, v36, v36, v3
    v_dot2_f32_bf16 v4, v37, s8, v4
    v_dot2_f32_bf16 v5, v37, v37, v5
    v_dot2_f32_bf16 v2, v38, s8, v2
    v_dot2_f32_bf16 v3, v38, v38, v3
    v_dot2_f32_bf16 v4, v39, s8, v4
    v_dot2_f32_bf16 v5, v39, v39, v5
    s_waitcnt lgkmcnt(4)
    v_dot2_f32_bf16 v2, v40, s8, v2
    v_dot2_f32_bf16 v3, v40, v40, v3
    v_dot2_f32_bf16 v4, v41, s8, v4
    v_dot2_f32_bf16 v5, v41, v41, v5
    v_dot2_f32_bf16 v2, v42, s8, v2
    v_dot2_f32_bf16 v3, v42, v42, v3
    v_dot2_f32_bf16 v4, v43, s8, v4
    v_dot2_f32_bf16 v5, v43, v43, v5
    s_waitcnt lgkmcnt(3)
    v_dot2_f32_bf16 v2, v44, s8, v2
    v_dot2_f32_bf16 v3, v44, v44, v3
    v_dot2_f32_bf16 v4, v45, s8, v4
    v_dot2_f32_bf16 v5, v45, v45, v5
    v_dot2_f32_bf16 v2, v46, s8, v2
    v_dot2_f32_bf16 v3, v46, v46, v3
    v_dot2_f32_bf16 v4, v47, s8, v4
    v_dot2_f32_bf16 v5, v47, v47, v5
    s_waitcnt lgkmcnt(2)
    v_dot2_f32_bf16 v2, v48, s8, v2
    v_dot2_f32_bf16 v3, v48, v48, v3
    v_dot2_f32_bf16 v4, v49, s8, v4
    v_dot2_f32_bf16 v5, v49, v49, v5
    v_dot2_f32_bf16 v2, v50, s8, v2
    v_dot2_f32_bf16 v3, v50, v50, v3
    v_dot2_f32_bf16 v4, v51, s8, v4
    v_dot2_f32_bf16 v5, v51, v51, v5
    s_waitcnt lgkmcnt(1)
    v_dot2_f32_bf16 v2, v52, s8, v2
    v_dot2_f32_bf16 v3, v52, v52, v3
    v_dot2_f32_bf16 v4, v53, s8, v4
    v_dot2_f32_bf16 v5, v53, v53, v5
    v_dot2_f32_bf16 v2, v54, s8, v2
    v_dot2_f32_bf16 v3, v54, v54, v3
    v_dot2_f32_bf16 v4, v55, s8, v4
    v_dot2_f32_bf16 v5, v55, v55, v5
    s_waitcnt lgkmcnt(0)
    v_dot2_f32_bf16 v2, v56, s8, v2
    v_dot2_f32_bf16 v3, v56, v56, v3
    v_dot2_f32_bf16 v4, v57, s8, v4
    v_dot2_f32_bf16 v5, v57, v57, v5
    v_dot2_f32_bf16 v2, v58, s8, v2
    v_dot2_f32_bf16 v3, v58, v58, v3
    v_dot2_f32_bf16 v4, v59, s8, v4
    v_dot2_f32_bf16 v5, v59, v59, v5
    s_nop 2
    v_add_f32 v2, v2, v4
    v_add_f32 v3, v3, v5
    s_nop 0
    v_add_f32 v2, v2, v2 quad_perm:[1,0,3,2]
    v_add_f32 v3, v3, v3 quad_perm:[1,0,3,2]
    s_nop 0
    v_add_f32 v2, v2, v2 quad_perm:[2,3,0,1]
    v_add_f32 v3, v3, v3 quad_perm:[2,3,0,1]
    s_nop 0
    v_add_f32 v2, v2, v2 row_half_mirror
    v_add_f32 v3, v3, v3 row_half_mirror
    s_nop 0
    v_mul_f32 v2, 0x3b124925, v2
    v_mul_f32 v3, 0x3b124925, v3
    s_mov_b32 s10, 0x01010101
    s_mov_b32 s11, 0x01010101
    v_fma_f32 v3, -v2, v2, v3
    v_max_f32 v3, 0, v3
    v_cvt_pk_bf16_f32 v7, v2, v3
    s_mov_b64 exec, s[10:11]
    v_and_b32 v4, 0xffff0000, v7
    v_lshlrev_b32 v7, 16, v7
    v_add_f32 v4, 0x3727c5ac, v4
    ds_write_b32 v17, v7 offset:128
    v_cvt_pk_bf16_f32 v4, v4, v4
    v_sub_f32 v2, v2, v7
    v_and_b32 v4, 0xffff0000, v4
    v_sqrt_f32 v4, v4
    s_nop 0
    v_cvt_pk_bf16_f32 v4, v4, v4
    v_and_b32 v4, 0xffff0000, v4
    v_rcp_f32 v4, v4
    s_cmp_lt_u32 s7, 2
    v_mul_f32 v5, v4, v4
    ds_write_b32 v17, v4
    s_cbranch_scc1 L_st2
    v_mul_f32 v2, v2, v4
    v_mul_f32 v5, v5, v3
    v_cvt_pk_bf16_f32 v2, v2, v5
    v_and_b32 v5, 0xffff0000, v2
    v_lshlrev_b32 v2, 16, v2
    v_add_f32 v5, 0x3727c5ac, v5
    v_fmac_f32 v2, v7, v4
    v_cvt_pk_bf16_f32 v5, v5, v5
    v_and_b32 v5, 0xffff0000, v5
    v_sqrt_f32 v5, v5
    s_nop 0
    v_cvt_pk_bf16_f32 v5, v5, v5
    v_and_b32 v5, 0xffff0000, v5
    v_rcp_f32 v5, v5
    s_nop 0
    v_mul_f32_e64 v6, -v2, v5
    v_mul_f32 v5, v4, v5
    ds_write_b32 v17, v5 offset:256
    ds_write_b32 v17, v6 offset:384
L_st2:
    s_mov_b64 exec, 1
    ds_add_u32 v20, v21 offset:8260
    s_mov_b64 exec, -1
    s_setprio 0
    s_mov_b32 exec_hi, 0x00ffffff
    s_mov_b32 s11, 22
L_wq1:
    buffer_load_dwordx4 v24, s[48:51], s9 offen lds
    s_add_u32 s15, s15, 1
    s_cmp_eq_u32 s15, 28
    s_cselect_b32 s10, -27, 1
    s_mul_i32 s10, s10, 896
    s_add_u32 m0, m0, s10
    s_lshl_b32 s10, s10, 2
    s_add_u32 s9, s9, s10
    s_sub_u32 s11, s11, 1
    s_waitcnt vmcnt(63)
    s_cmp_lg_u32 s11, 0
    s_cbranch_scc1 L_wq1
    s_mov_b64 exec, -1
    s_mov_b32 s84, s40
    s_and_b32 s85, s41, 0xffff
    s_mov_b32 s86, 16777216
    s_mov_b32 s87, 0x20000
    s_mov_b32 s80, s38
    s_and_b32 s81, s39, 0xffff
    s_mov_b32 s82, 256
    s_mov_b32 s83, 0x20000
    v_and_b32 v2, 15, v1
    v_bfe_u32 v3, v1, 4, 1
    v_lshrrev_b32 v4, 5, v1
    v_lshrrev_b32 v5, 2, v2
    v_lshl_add_u32 v5, v4, 3, v5
    v_mul_u32_u24 v5, 224, v5
    v_and_b32 v6, 3, v2
    v_lshlrev_b32 v6, 3, v6
    v_lshl_add_u32 v6, v3, 5, v6
    v_add_u32 v5, v5, v6
    s_mul_i32 s8, s92, 56
    s_add_u32 s8, s8, 37888
    v_add_u32 v5, s8, v5
    v_add_u32 v6, 50176, v5
    v_and_b32 v7, 31, v1
    v_mul_u32_u24 v7, 912, v7
    v_lshl_add_u32 v7, v4, 4, v7
    v_and_b32 v9, 31, v1
    v_lshlrev_b32 v9, 2, v9
    v_add_u32 v9, 163328, v9
    v_mov_b32 v64, 0x3f803f80
    v_mov_b32 v65, 0x3f803f80
    v_mov_b32 v66, 0x3f803f80
    v_mov_b32 v67, 0x3f803f80
    ds_read_b128 v[144:147], v7 offset:8704
    ds_read_b128 v[148:151], v7 offset:8736
    ds_read_b128 v[152:155], v7 offset:8768
    ds_read_b128 v[156:159], v7 offset:8800
    ds_read_b128 v[160:163], v7 offset:8832
    ds_read_b128 v[164:167], v7 offset:8864
    ds_read_b128 v[168:171], v7 offset:8896
    ds_read_b128 v[172:175], v7 offset:8928
    ds_read_b128 v[176:179], v7 offset:8960
    ds_read_b128 v[180:183], v7 offset:8992
    ds_read_b128 v[184:187], v7 offset:9024
    ds_read_b128 v[188:191], v7 offset:9056
    ds_read_b128 v[192:195], v7 offset:9088
    ds_read_b128 v[196:199], v7 offset:9120
    ds_read_b128 v[200:203], v7 offset:9152
    ds_read_b128 v[204:207], v7 offset:9184
    ds_read_b128 v[208:211], v7 offset:9216
    ds_read_b128 v[212:215], v7 offset:9248
    ds_read_b128 v[216:219], v7 offset:9280
    ds_read_b128 v[220:223], v7 offset:9312
    ds_read_b128 v[224:227], v7 offset:9344
    ds_read_b128 v[228:231], v7 offset:9376
    ds_read_b128 v[232:235], v7 offset:9408
    ds_read_b128 v[236:239], v7 offset:9440
    ds_read_b128 v[240:243], v7 offset:9472
    ds_read_b128 v[244:247], v7 offset:9504
    ds_read_b128 v[248:251], v7 offset:9536
    ds_read_b128 v[252:255], v7 offset:9568
    s_mov_b32 s14, 0
L_ls_13:
    ds_read_b32 v22, v20 offset:8260
    s_add_u32 s14, s14, 1
    s_waitcnt lgkmcnt(0)
    v_readfirstlane_b32 s13, v22
    s_cmp_gt_u32 s14, 1600000
    s_cbranch_scc1 L_lsd_14
    s_cmp_ge_u32 s13, 4
    s_cbranch_scc1 L_lsd_14
    s_branch L_ls_13
L_lsd_14:
    ds_read_b32 v68, v9 offset:128
    ds_read_b32 v70, v9
    s_waitcnt lgkmcnt(0)
    v_mul_f32 v70, 0x3e8b97f6, v70
    v_mul_f32_e64 v68, -v68, v70
    s_waitcnt vmcnt(0)
    s_mov_b64 exec, 1
    ds_add_u32 v20, v21 offset:8256
    s_mov_b64 exec, -1
    s_mov_b32 s14, 0
L_ls_15:
    ds_read_b32 v22, v20 offset:8256
    s_add_u32 s14, s14, 1
    s_waitcnt lgkmcnt(0)
    v_readfirstlane_b32 s13, v22
    s_cmp_gt_u32 s14, 1600000
    s_cbranch_scc1 L_lsd_16
    s_cmp_ge_u32 s13, 4
    s_cbranch_scc1 L_lsd_16
    s_branch L_ls_15
L_lsd_16:
    ds_read_b64_tr_b16 v[80:81], v5 offset:0
    ds_read_b64_tr_b16 v[82:83], v5 offset:896
    ds_read_b64_tr_b16 v[84:85], v5 offset:3584
    ds_read_b64_tr_b16 v[86:87], v5 offset:4480
    ds_read_b64_tr_b16 v[88:89], v5 offset:7168
    ds_read_b64_tr_b16 v[90:91], v5 offset:8064
    ds_read_b64_tr_b16 v[92:93], v5 offset:10752
    ds_read_b64_tr_b16 v[94:95], v5 offset:11648
    ds_read_b64_tr_b16 v[96:97], v5 offset:14336
    ds_read_b64_tr_b16 v[98:99], v5 offset:15232
    ds_read_b64_tr_b16 v[100:101], v5 offset:17920
    ds_read_b64_tr_b16 v[102:103], v5 offset:18816
    ds_read_b64_tr_b16 v[104:105], v5 offset:21504
    ds_read_b64_tr_b16 v[106:107], v5 offset:22400
    ds_read_b64_tr_b16 v[108:109], v5 offset:25088
    ds_read_b64_tr_b16 v[110:111], v5 offset:25984
    ds_read_b64_tr_b16 v[112:113], v5 offset:28672
    ds_read_b64_tr_b16 v[114:115], v5 offset:29568
    ds_read_b64_tr_b16 v[116:117], v5 offset:32256
    ds_read_b64_tr_b16 v[118:119], v5 offset:33152
    ds_read_b64_tr_b16 v[120:121], v5 offset:35840
    ds_read_b64_tr_b16 v[122:123], v5 offset:36736
    ds_read_b64_tr_b16 v[124:125], v5 offset:39424
    ds_read_b64_tr_b16 v[126:127], v5 offset:40320
    ds_read_b64_tr_b16 v[128:129], v5 offset:43008
    ds_read_b64_tr_b16 v[130:131], v5 offset:43904
    ds_read_b64_tr_b16 v[132:133], v5 offset:46592
    ds_read_b64_tr_b16 v[134:135], v5 offset:47488
    ds_read_b64_tr_b16 v[136:137], v6 offset:0
    ds_read_b64_tr_b16 v[138:139], v6 offset:896
    ds_read_b64_tr_b16 v[140:141], v6 offset:3584
    ds_read_b64_tr_b16 v[142:143], v6 offset:4480
    s_waitcnt lgkmcnt(15)
    v_mfma_f32_32x32x16_bf16 v[32:47], v[80:83], v[144:147], 0
    v_mfma_f32_32x32x16_bf16 v[48:63], v[80:83], v[64:67], 0
    ds_read_b64_tr_b16 v[80:81], v6 offset:7168
    ds_read_b64_tr_b16 v[82:83], v6 offset:8064
    ds_read_b64_tr_b16 v[144:145], v6 offset:10752
    ds_read_b64_tr_b16 v[146:147], v6 offset:11648
    s_waitcnt lgkmcnt(15)
    v_mfma_f32_32x32x16_bf16 v[32:47], v[84:87], v[148:151], v[32:47]
    v_mfma_f32_32x32x16_bf16 v[48:63], v[84:87], v[64:67], v[48:63]
    ds_read_b64_tr_b16 v[84:85], v6 offset:14336
    ds_read_b64_tr_b16 v[86:87], v6 offset:15232
    ds_read_b64_tr_b16 v[148:149], v6 offset:17920
    ds_read_b64_tr_b16 v[150:151], v6 offset:18816
    s_waitcnt lgkmcnt(15)
    v_mfma_f32_32x32x16_bf16 v[32:47], v[88:91], v[152:155], v[32:47]
    v_mfma_f32_32x32x16_bf16 v[48:63], v[88:91], v[64:67], v[48:63]
    ds_read_b64_tr_b16 v[88:89], v6 offset:21504
    ds_read_b64_tr_b16 v[90:91], v6 offset:22400
    ds_read_b64_tr_b16 v[152:153], v6 offset:25088
    ds_read_b64_tr_b16 v[154:155], v6 offset:25984
    s_waitcnt lgkmcnt(15)
    v_mfma_f32_32x32x16_bf16 v[32:47], v[92:95], v[156:159], v[32:47]
    v_mfma_f32_32x32x16_bf16 v[48:63], v[92:95], v[64:67], v[48:63]
    ds_read_b64_tr_b16 v[92:93], v6 offset:28672
    ds_read_b64_tr_b16 v[94:95], v6 offset:29568
    ds_read_b64_tr_b16 v[156:157], v6 offset:32256
    ds_read_b64_tr_b16 v[158:159], v6 offset:33152
    s_waitcnt lgkmcnt(15)
    v_mfma_f32_32x32x16_bf16 v[32:47], v[96:99], v[160:163], v[32:47]
    v_mfma_f32_32x32x16_bf16 v[48:63], v[96:99], v[64:67], v[48:63]
    ds_read_b64_tr_b16 v[96:97], v6 offset:35840
    ds_read_b64_tr_b16 v[98:99], v6 offset:36736
    ds_read_b64_tr_b16 v[160:161], v6 offset:39424
    ds_read_b64_tr_b16 v[162:163], v6 offset:40320
    s_waitcnt lgkmcnt(15)
    v_mfma_f32_32x32x16_bf16 v[32:47], v[100:103], v[164:167], v[32:47]
    v_mfma_f32_32x32x16_bf16 v[48:63], v[100:103], v[64:67], v[48:63]
    ds_read_b64_tr_b16 v[100:101], v6 offset:43008
    ds_read_b64_tr_b16 v[102:103], v6 offset:43904
    ds_read_b64_tr_b16 v[164:165], v6 offset:46592
    ds_read_b64_tr_b16 v[166:167], v6 offset:47488
    s_waitcnt lgkmcnt(15)
    v_mfma_f32_32x32x16_bf16 v[32:47], v[104:107], v[168:171], v[32:47]
    v_mfma_f32_32x32x16_bf16 v[48:63], v[104:107], v[64:67], v[48:63]
    s_waitcnt lgkmcnt(0)
    s_mov_b64 exec, 1
    ds_add_u32 v20, v21 offset:8264
    s_mov_b64 exec, -1
    v_mfma_f32_32x32x16_bf16 v[32:47], v[108:111], v[172:175], v[32:47]
    v_mfma_f32_32x32x16_bf16 v[48:63], v[108:111], v[64:67], v[48:63]
    v_mfma_f32_32x32x16_bf16 v[32:47], v[112:115], v[176:179], v[32:47]
    v_mfma_f32_32x32x16_bf16 v[48:63], v[112:115], v[64:67], v[48:63]
    s_mov_b32 s14, 0
L_ls_17:
    ds_read_b32 v22, v20 offset:8216
    s_add_u32 s14, s14, 1
    s_waitcnt lgkmcnt(0)
    v_readfirstlane_b32 s13, v22
    s_cmp_gt_u32 s14, 1600000
    s_cbranch_scc1 L_lsd_18
    s_cmp_ge_u32 s13, 4
    s_cbranch_scc1 L_lsd_18
    s_branch L_ls_17
L_lsd_18:
    v_mfma_f32_32x32x16_bf16 v[32:47], v[116:119], v[180:183], v[32:47]
    v_mfma_f32_32x32x16_bf16 v[48:63], v[116:119], v[64:67], v[48:63]
    v_mfma_f32_32x32x16_bf16 v[32:47], v[120:123], v[184:187], v[32:47]
    v_mfma_f32_32x32x16_bf16 v[48:63], v[120:123], v[64:67], v[48:63]
    v_mfma_f32_32x32x16_bf16 v[32:47], v[124:127], v[188:191], v[32:47]
    v_mfma_f32_32x32x16_bf16 v[48:63], v[124:127], v[64:67], v[48:63]
    v_mfma_f32_32x32x16_bf16 v[32:47], v[128:131], v[192:195], v[32:47]
    v_mfma_f32_32x32x16_bf16 v[48:63], v[128:131], v[64:67], v[48:63]
    v_mfma_f32_32x32x16_bf16 v[32:47], v[132:135], v[196:199], v[32:47]
    v_mfma_f32_32x32x16_bf16 v[48:63], v[132:135], v[64:67], v[48:63]
    v_mfma_f32_32x32x16_bf16 v[32:47], v[136:139], v[200:203], v[32:47]
    v_mfma_f32_32x32x16_bf16 v[48:63], v[136:139], v[64:67], v[48:63]
    v_mfma_f32_32x32x16_bf16 v[32:47], v[140:143], v[204:207], v[32:47]
    v_mfma_f32_32x32x16_bf16 v[48:63], v[140:143], v[64:67], v[48:63]
    v_mfma_f32_32x32x16_bf16 v[32:47], v[80:83], v[208:211], v[32:47]
    v_mfma_f32_32x32x16_bf16 v[48:63], v[80:83], v[64:67], v[48:63]
    v_mfma_f32_32x32x16_bf16 v[32:47], v[144:147], v[212:215], v[32:47]
    v_mfma_f32_32x32x16_bf16 v[48:63], v[144:147], v[64:67], v[48:63]
    v_mfma_f32_32x32x16_bf16 v[32:47], v[84:87], v[216:219], v[32:47]
    v_mfma_f32_32x32x16_bf16 v[48:63], v[84:87], v[64:67], v[48:63]
    v_mfma_f32_32x32x16_bf16 v[32:47], v[148:151], v[220:223], v[32:47]
    v_mfma_f32_32x32x16_bf16 v[48:63], v[148:151], v[64:67], v[48:63]
    v_mfma_f32_32x32x16_bf16 v[32:47], v[88:91], v[224:227], v[32:47]
    v_mfma_f32_32x32x16_bf16 v[48:63], v[88:91], v[64:67], v[48:63]
    v_mfma_f32_32x32x16_bf16 v[32:47], v[152:155], v[228:231], v[32:47]
    v_mfma_f32_32x32x16_bf16 v[48:63], v[152:155], v[64:67], v[48:63]
    v_mfma_f32_32x32x16_bf16 v[32:47], v[92:95], v[232:235], v[32:47]
    v_mfma_f32_32x32x16_bf16 v[48:63], v[92:95], v[64:67], v[48:63]
    s_lshl_b32 s9, s2, 10
    s_add_u32 s9, s9, 6291456
    s_mov_b32 s18, 0
    s_cmp_lg_u32 s92, 0
    s_cbranch_scc1 L_anp
    s_load_dword s18, s[84:85], s9 glc
L_anp:
    v_mfma_f32_32x32x16_bf16 v[32:47], v[156:159], v[236:239], v[32:47]
    v_mfma_f32_32x32x16_bf16 v[48:63], v[156:159], v[64:67], v[48:63]
    v_mfma_f32_32x32x16_bf16 v[32:47], v[96:99], v[240:243], v[32:47]
    v_mfma_f32_32x32x16_bf16 v[48:63], v[96:99], v[64:67], v[48:63]
    v_mfma_f32_32x32x16_bf16 v[32:47], v[160:163], v[244:247], v[32:47]
    v_mfma_f32_32x32x16_bf16 v[48:63], v[160:163], v[64:67], v[48:63]
    v_mfma_f32_32x32x16_bf16 v[32:47], v[100:103], v[248:251], v[32:47]
    v_mfma_f32_32x32x16_bf16 v[48:63], v[100:103], v[64:67], v[48:63]
    v_mfma_f32_32x32x16_bf16 v[32:47], v[164:167], v[252:255], v[32:47]
    v_mfma_f32_32x32x16_bf16 v[48:63], v[164:167], v[64:67], v[48:63]
    s_lshl_b32 s10, s92, 11
    v_add_u32 v8, s10, v23
    s_nop 8
    v_pk_mul_f32 v[32:33], v[32:33], v[70:71] op_sel_hi:[1,0]
    v_pk_mul_f32 v[34:35], v[34:35], v[70:71] op_sel_hi:[1,0]
    v_pk_mul_f32 v[36:37], v[36:37], v[70:71] op_sel_hi:[1,0]
    v_pk_mul_f32 v[38:39], v[38:39], v[70:71] op_sel_hi:[1,0]
    v_pk_mul_f32 v[40:41], v[40:41], v[70:71] op_sel_hi:[1,0]
    v_pk_mul_f32 v[42:43], v[42:43], v[70:71] op_sel_hi:[1,0]
    v_pk_mul_f32 v[44:45], v[44:45], v[70:71] op_sel_hi:[1,0]
    v_pk_mul_f32 v[46:47], v[46:47], v[70:71] op_sel_hi:[1,0]
    v_pk_fma_f32 v[32:33], v[48:49], v[68:69], v[32:33] op_sel_hi:[1,0,1]
    v_pk_fma_f32 v[34:35], v[50:51], v[68:69], v[34:35] op_sel_hi:[1,0,1]
    v_pk_fma_f32 v[36:37], v[52:53], v[68:69], v[36:37] op_sel_hi:[1,0,1]
    v_pk_fma_f32 v[38:39], v[54:55], v[68:69], v[38:39] op_sel_hi:[1,0,1]
    v_pk_fma_f32 v[40:41], v[56:57], v[68:69], v[40:41] op_sel_hi:[1,0,1]
    v_pk_fma_f32 v[42:43], v[58:59], v[68:69], v[42:43] op_sel_hi:[1,0,1]
    v_pk_fma_f32 v[44:45], v[60:61], v[68:69], v[44:45] op_sel_hi:[1,0,1]
    v_pk_fma_f32 v[46:47], v[62:63], v[68:69], v[46:47] op_sel_hi:[1,0,1]
    v_cvt_pk_bf16_f32 v80, v32, v33
    v_cvt_pk_bf16_f32 v81, v34, v35
    v_cvt_pk_bf16_f32 v82, v36, v37
    v_cvt_pk_bf16_f32 v83, v38, v39
    v_cvt_pk_bf16_f32 v84, v40, v41
    v_cvt_pk_bf16_f32 v85, v42, v43
    v_cvt_pk_bf16_f32 v86, v44, v45
    v_cvt_pk_bf16_f32 v87, v46, v47
    s_mov_b32 exec_lo, 0
    v_mov_b32 v86, 0
    v_mov_b32 v87, 0
    s_mov_b64 exec, -1
    ds_write_b128 v8, v[80:83] offset:0
    ds_write_b128 v8, v[84:87] offset:1024
    s_mov_b64 exec, 1
    ds_add_u32 v20, v21 offset:8220
    s_mov_b64 exec, -1
    s_mov_b32 s48, s40
    s_and_b32 s49, s41, 0xffff
    s_mov_b32 s50, 262144
    s_mov_b32 s51, 0x20000
    s_lshl_b32 s8, s92, 16
    v_add_u32 v10, s8, v23
    s_mov_b32 s100, 0
    v_mov_b32 v12, 0
    v_mov_b32 v13, 0
    v_mov_b32 v14, 0
    v_mov_b32 v15, 0
    s_setprio 3
    s_cmp_lg_u32 s92, 0
    s_cbranch_scc1 L_nopoll
    s_waitcnt lgkmcnt(0)
    s_cmp_ge_u32 s18, 1
    s_cbranch_scc1 L_agok
    s_lshl_b32 s9, s2, 10
    s_add_u32 s9, s9, 6291456
    s_mov_b32 s14, 0
L_sp_19:
    s_load_dword s13, s[84:85], s9 offset:0 glc
    s_add_u32 s14, s14, 1
    s_waitcnt lgkmcnt(0)
    s_cmp_ge_u32 s13, 1
    s_cbranch_scc1 L_spd_20
    s_cmp_gt_u32 s14, 400000
    s_cbranch_scc0 L_sp_19
L_spd_20:
L_agok:
    s_mov_b64 exec, 1
    ds_add_u32 v20, v21 offset:8224
    s_mov_b64 exec, -1
    s_branch L_att_restart
L_nopoll:
    s_mov_b32 s14, 0
L_ls_21:
    ds_read_b32 v22, v20 offset:8224
    s_add_u32 s14, s14, 1
    s_waitcnt lgkmcnt(0)
    v_readfirstlane_b32 s13, v22
    s_cmp_gt_u32 s14, 1600000
    s_cbranch_scc1 L_lsd_22
    s_cmp_ge_u32 s13, 1
    s_cbranch_scc1 L_lsd_22
    s_branch L_ls_21
L_lsd_22:
L_att_restart:
    s_and_b32 s99, s5, 15
    s_lshl_b32 s99, s99, 12
    s_mov_b32 s50, 0x40000
    s_setprio 3
    buffer_load_dwordx4 v[128:131], v10, s[48:51], s99 offen offset:0 sc1
    buffer_load_dwordx4 v[132:135], v10, s[48:51], s99 offen offset:1024 sc1
    buffer_load_dwordx4 v[136:139], v10, s[48:51], s99 offen offset:2048 sc1
    buffer_load_dwordx4 v[140:143], v10, s[48:51], s99 offen offset:3072 sc1
    s_setprio 1
    s_add_u32 s99, s99, 4096
    s_and_b32 s99, s99, 0xffff
    s_setprio 3
    buffer_load_dwordx4 v[144:147], v10, s[48:51], s99 offen offset:0 sc1
    buffer_load_dwordx4 v[148:151], v10, s[48:51], s99 offen offset:1024 sc1
    buffer_load_dwordx4 v[152:155], v10, s[48:51], s99 offen offset:2048 sc1
    buffer_load_dwordx4 v[156:159], v10, s[48:51], s99 offen offset:3072 sc1
    s_setprio 1
    s_add_u32 s99, s99, 4096
    s_and_b32 s99, s99, 0xffff
    s_setprio 3
    buffer_load_dwordx4 v[160:163], v10, s[48:51], s99 offen offset:0 sc1
    buffer_load_dwordx4 v[164:167], v10, s[48:51], s99 offen offset:1024 sc1
    buffer_load_dwordx4 v[168:171], v10, s[48:51], s99 offen offset:2048 sc1
    buffer_load_dwordx4 v[172:175], v10, s[48:51], s99 offen offset:3072 sc1
    s_setprio 1
    s_add_u32 s99, s99, 4096
    s_and_b32 s99, s99, 0xffff
    s_cmp_lg_u32 s100, 0
    s_cbranch_scc1 L_go
    s_mov_b32 s14, 0
L_ls_23:
    ds_read_b32 v22, v20 offset:8220
    s_add_u32 s14, s14, 1
    s_waitcnt lgkmcnt(0)
    v_readfirstlane_b32 s13, v22
    s_cmp_gt_u32 s14, 1600000
    s_cbranch_scc1 L_lsd_24
    s_cmp_ge_u32 s13, 4
    s_cbranch_scc1 L_lsd_24
    s_branch L_ls_23
L_lsd_24:
    s_xor_b32 s10, s92, 0
    s_lshl_b32 s10, s10, 11
    v_add_u32 v8, s10, v23
    ds_read_b128 v[32:35], v8 offset:0
    ds_read_b128 v[36:39], v8 offset:1024
    s_xor_b32 s10, s92, 1
    s_lshl_b32 s10, s10, 11
    v_add_u32 v8, s10, v23
    ds_read_b128 v[40:43], v8 offset:0
    ds_read_b128 v[44:47], v8 offset:1024
    s_xor_b32 s10, s92, 2
    s_lshl_b32 s10, s10, 11
    v_add_u32 v8, s10, v23
    ds_read_b128 v[48:51], v8 offset:0
    ds_read_b128 v[52:55], v8 offset:1024
    s_xor_b32 s10, s92, 3
    s_lshl_b32 s10, s10, 11
    v_add_u32 v8, s10, v23
    ds_read_b128 v[56:59], v8 offset:0
    ds_read_b128 v[60:63], v8 offset:1024
    s_mul_i32 s11, s92, 32768
    s_add_u32 s11, s11, 33280
    v_add_u32 v8, s11, v23
    s_lshl_b32 s11, s92, 12
    s_add_u32 s11, s11, 139776
    v_add_u32 v5, s11, v23
    v_lshrrev_b32 v11, 2, v23
    s_lshl_b32 s10, s92, 10
    v_add_u32 v9, s10, v11
    s_lshr_b32 s8, s6, 1
    s_lshl_b32 s8, s8, 5
    s_lshl_b32 s9, s7, 3
    s_add_u32 s8, s8, s9
    s_lshl_b32 s9, s92, 1
    s_add_u32 s8, s8, s9
    s_lshl_b32 s8, s8, 1
    s_and_b32 s9, s6, 1
    s_add_u32 s8, s8, s9
    s_lshl_b32 s8, s8, 10
    s_add_u32 s16, s8, 4194304
    s_lshr_b32 s12, s6, 1
    s_lshl_b32 s12, s12, 2
    s_add_u32 s12, s12, s7
    s_lshl_b32 s12, s12, 10
    s_add_u32 s17, s12, 6292352
    s_xor_b32 s10, s92, 1
    s_lshl_b32 s11, s10, 10
    v_add_u32 v16, s11, v11
    s_mul_i32 s10, s10, 32768
    s_add_u32 s10, s10, 33280
    v_add_u32 v2, s10, v23
    s_xor_b32 s10, s92, 2
    s_lshl_b32 s11, s10, 10
    v_add_u32 v17, s11, v11
    s_mul_i32 s10, s10, 32768
    s_add_u32 s10, s10, 37376
    v_add_u32 v3, s10, v23
    s_xor_b32 s10, s92, 3
    s_lshl_b32 s11, s10, 10
    v_add_u32 v18, s11, v11
    s_mul_i32 s10, s10, 4096
    s_add_u32 s10, s10, 139776
    v_add_u32 v4, s10, v23
L_go:
    v_mov_b32 v64, 0
    v_mov_b32 v65, 0
    v_mov_b32 v66, 0
    v_mov_b32 v67, 0
    v_mov_b32 v68, 0
    v_mov_b32 v69, 0
    v_mov_b32 v70, 0
    v_mov_b32 v71, 0
    v_mov_b32 v72, 0
    v_mov_b32 v73, 0
    v_mov_b32 v74, 0
    v_mov_b32 v75, 0
    v_mov_b32 v76, 0
    v_mov_b32 v77, 0
    v_mov_b32 v78, 0
    v_mov_b32 v79, 0
    v_mov_b32 v80, 0
    v_mov_b32 v81, 0
    v_mov_b32 v82, 0
    v_mov_b32 v83, 0
    v_mov_b32 v84, 0
    v_mov_b32 v85, 0
    v_mov_b32 v86, 0
    v_mov_b32 v87, 0
    v_mov_b32 v88, 0
    v_mov_b32 v89, 0
    v_mov_b32 v90, 0
    v_mov_b32 v91, 0
    v_mov_b32 v92, 0
    v_mov_b32 v93, 0
    v_mov_b32 v94, 0
    v_mov_b32 v95, 0
    v_mov_b32 v96, 0
    v_mov_b32 v97, 0
    v_mov_b32 v98, 0
    v_mov_b32 v99, 0
    v_mov_b32 v100, 0
    v_mov_b32 v101, 0
    v_mov_b32 v102, 0
    v_mov_b32 v103, 0
    v_mov_b32 v104, 0
    v_mov_b32 v105, 0
    v_mov_b32 v106, 0
    v_mov_b32 v107, 0
    v_mov_b32 v108, 0
    v_mov_b32 v109, 0
    v_mov_b32 v110, 0
    v_mov_b32 v111, 0
    v_mov_b32 v112, 0
    v_mov_b32 v113, 0
    v_mov_b32 v114, 0
    v_mov_b32 v115, 0
    v_mov_b32 v116, 0
    v_mov_b32 v117, 0
    v_mov_b32 v118, 0
    v_mov_b32 v119, 0
    v_mov_b32 v120, 0
    v_mov_b32 v121, 0
    v_mov_b32 v122, 0
    v_mov_b32 v123, 0
    v_mov_b32 v124, 0
    v_mov_b32 v125, 0
    v_mov_b32 v126, 0
    v_mov_b32 v127, 0
    v_mov_b32 v244, 0
    v_mov_b32 v245, 0
    v_mov_b32 v246, 0
    v_mov_b32 v247, 0
    v_mov_b32 v188, 0
    v_mov_b32 v189, 0
    v_mov_b32 v190, 0
    v_mov_b32 v191, 0
    s_waitcnt vmcnt(10) lgkmcnt(0)
    v_mfma_f32_32x32x16_bf16 v[208:223], v[128:131], v[32:35], 0
    v_mfma_f32_32x32x16_bf16 v[208:223], v[132:135], v[36:39], v[208:223]
    s_mov_b32 s12, 4
    s_nop 10
    .p2align 6
L_attloop:
    v_mfma_f32_32x32x16_bf16 v[224:239], v[128:131], v[40:43], 0
    v_exp_f32 v208, v208
    v_exp_f32 v209, v209
    v_exp_f32 v210, v210
    v_exp_f32 v211, v211
    v_cvt_pk_bf16_f32 v240, v208, v209
    v_cvt_pk_bf16_f32 v241, v210, v211
    v_mfma_f32_32x32x16_bf16 v[224:239], v[132:135], v[44:47], v[224:239]
    v_exp_f32 v212, v212
    v_exp_f32 v213, v213
    v_exp_f32 v214, v214
    v_exp_f32 v215, v215
    v_cvt_pk_bf16_f32 v242, v212, v213
    v_cvt_pk_bf16_f32 v243, v214, v215
    v_mfma_f32_32x32x16_bf16 v[112:127], v[188:191], v[244:247], v[112:127]
    s_setprio 3
    buffer_load_dwordx4 v[176:179], v10, s[48:51], s99 offen offset:0 sc1
    buffer_load_dwordx4 v[180:183], v10, s[48:51], s99 offen offset:1024 sc1
    buffer_load_dwordx4 v[184:187], v10, s[48:51], s99 offen offset:2048 sc1
    buffer_load_dwordx4 v[188:191], v10, s[48:51], s99 offen offset:3072 sc1
    s_setprio 1
    s_add_u32 s99, s99, 4096
    s_and_b32 s99, s99, 0xffff
    v_exp_f32 v216, v216
    v_exp_f32 v217, v217
    v_exp_f32 v218, v218
    v_exp_f32 v219, v219
    v_cvt_pk_bf16_f32 v244, v216, v217
    v_cvt_pk_bf16_f32 v245, v218, v219
    s_waitcnt vmcnt(12)
    v_mfma_f32_32x32x16_bf16 v[64:79], v[136:139], v[240:243], v[64:79]
    v_exp_f32 v220, v220
    v_exp_f32 v221, v221
    v_exp_f32 v222, v222
    v_exp_f32 v223, v223
    v_cvt_pk_bf16_f32 v246, v220, v221
    v_cvt_pk_bf16_f32 v247, v222, v223
    v_mfma_f32_32x32x16_bf16 v[208:223], v[128:131], v[48:51], 0
    v_exp_f32 v224, v224
    v_exp_f32 v225, v225
    v_exp_f32 v226, v226
    v_exp_f32 v227, v227
    v_cvt_pk_bf16_f32 v240, v224, v225
    v_cvt_pk_bf16_f32 v241, v226, v227
    v_mfma_f32_32x32x16_bf16 v[208:223], v[132:135], v[52:55], v[208:223]
    v_exp_f32 v228, v228
    v_exp_f32 v229, v229
    v_exp_f32 v230, v230
    v_exp_f32 v231, v231
    v_cvt_pk_bf16_f32 v242, v228, v229
    v_cvt_pk_bf16_f32 v243, v230, v231
    v_mfma_f32_32x32x16_bf16 v[64:79], v[140:143], v[244:247], v[64:79]
    v_exp_f32 v232, v232
    v_exp_f32 v233, v233
    v_exp_f32 v234, v234
    v_exp_f32 v235, v235
    v_cvt_pk_bf16_f32 v244, v232, v233
    v_cvt_pk_bf16_f32 v245, v234, v235
    v_mfma_f32_32x32x16_bf16 v[80:95], v[136:139], v[240:243], v[80:95]
    v_exp_f32 v236, v236
    v_exp_f32 v237, v237
    v_exp_f32 v238, v238
    v_exp_f32 v239, v239
    v_cvt_pk_bf16_f32 v246, v236, v237
    v_cvt_pk_bf16_f32 v247, v238, v239
    v_mfma_f32_32x32x16_bf16 v[224:239], v[128:131], v[56:59], 0
    v_exp_f32 v208, v208
    v_exp_f32 v209, v209
    v_exp_f32 v210, v210
    v_exp_f32 v211, v211
    v_cvt_pk_bf16_f32 v240, v208, v209
    v_cvt_pk_bf16_f32 v241, v210, v211
    v_mfma_f32_32x32x16_bf16 v[224:239], v[132:135], v[60:63], v[224:239]
    v_exp_f32 v212, v212
    v_exp_f32 v213, v213
    v_exp_f32 v214, v214
    v_exp_f32 v215, v215
    v_cvt_pk_bf16_f32 v242, v212, v213
    v_cvt_pk_bf16_f32 v243, v214, v215
    v_mfma_f32_32x32x16_bf16 v[80:95], v[140:143], v[244:247], v[80:95]
    v_exp_f32 v216, v216
    v_exp_f32 v217, v217
    v_exp_f32 v218, v218
    v_exp_f32 v219, v219
    v_cvt_pk_bf16_f32 v244, v216, v217
    v_cvt_pk_bf16_f32 v245, v218, v219
    v_mfma_f32_32x32x16_bf16 v[96:111], v[136:139], v[240:243], v[96:111]
    v_exp_f32 v220, v220
    v_exp_f32 v221, v221
    v_exp_f32 v222, v222
    v_exp_f32 v223, v223
    v_cvt_pk_bf16_f32 v246, v220, v221
    v_cvt_pk_bf16_f32 v247, v222, v223
    s_waitcnt vmcnt(10)
    v_mfma_f32_32x32x16_bf16 v[208:223], v[144:147], v[32:35], 0
    v_exp_f32 v224, v224
    v_exp_f32 v225, v225
    v_exp_f32 v226, v226
    v_exp_f32 v227, v227
    v_cvt_pk_bf16_f32 v240, v224, v225
    v_cvt_pk_bf16_f32 v241, v226, v227
    v_mfma_f32_32x32x16_bf16 v[208:223], v[148:151], v[36:39], v[208:223]
    v_exp_f32 v228, v228
    v_exp_f32 v229, v229
    v_exp_f32 v230, v230
    v_exp_f32 v231, v231
    v_cvt_pk_bf16_f32 v242, v228, v229
    v_cvt_pk_bf16_f32 v243, v230, v231
    v_mfma_f32_32x32x16_bf16 v[96:111], v[140:143], v[244:247], v[96:111]
    v_exp_f32 v232, v232
    v_exp_f32 v233, v233
    v_exp_f32 v234, v234
    v_exp_f32 v235, v235
    v_cvt_pk_bf16_f32 v244, v232, v233
    v_cvt_pk_bf16_f32 v245, v234, v235
    v_mfma_f32_32x32x16_bf16 v[112:127], v[136:139], v[240:243], v[112:127]
    v_exp_f32 v236, v236
    v_exp_f32 v237, v237
    v_exp_f32 v238, v238
    v_exp_f32 v239, v239
    v_cvt_pk_bf16_f32 v246, v236, v237
    v_cvt_pk_bf16_f32 v247, v238, v239
    v_mfma_f32_32x32x16_bf16 v[224:239], v[144:147], v[40:43], 0
    v_exp_f32 v208, v208
    v_exp_f32 v209, v209
    v_exp_f32 v210, v210
    v_exp_f32 v211, v211
    v_cvt_pk_bf16_f32 v240, v208, v209
    v_cvt_pk_bf16_f32 v241, v210, v211
    v_mfma_f32_32x32x16_bf16 v[224:239], v[148:151], v[44:47], v[224:239]
    v_exp_f32 v212, v212
    v_exp_f32 v213, v213
    v_exp_f32 v214, v214
    v_exp_f32 v215, v215
    v_cvt_pk_bf16_f32 v242, v212, v213
    v_cvt_pk_bf16_f32 v243, v214, v215
    v_mfma_f32_32x32x16_bf16 v[112:127], v[140:143], v[244:247], v[112:127]
    s_cmp_eq_u32 s12, 1
    s_cselect_b32 s50, 0, s50
    s_setprio 3
    buffer_load_dwordx4 v[128:131], v10, s[48:51], s99 offen offset:0 sc1
    buffer_load_dwordx4 v[132:135], v10, s[48:51], s99 offen offset:1024 sc1
    buffer_load_dwordx4 v[136:139], v10, s[48:51], s99 offen offset:2048 sc1
    buffer_load_dwordx4 v[140:143], v10, s[48:51], s99 offen offset:3072 sc1
    s_setprio 1
    s_add_u32 s99, s99, 4096
    s_and_b32 s99, s99, 0xffff
    v_exp_f32 v216, v216
    v_exp_f32 v217, v217
    v_exp_f32 v218, v218
    v_exp_f32 v219, v219
    v_cvt_pk_bf16_f32 v244, v216, v217
    v_cvt_pk_bf16_f32 v245, v218, v219
    s_waitcnt vmcnt(12)
    v_mfma_f32_32x32x16_bf16 v[64:79], v[152:155], v[240:243], v[64:79]
    v_exp_f32 v220, v220
    v_exp_f32 v221, v221
    v_exp_f32 v222, v222
    v_exp_f32 v223, v223
    v_cvt_pk_bf16_f32 v246, v220, v221
    v_cvt_pk_bf16_f32 v247, v222, v223
    v_mfma_f32_32x32x16_bf16 v[208:223], v[144:147], v[48:51], 0
    v_exp_f32 v224, v224
    v_exp_f32 v225, v225
    v_exp_f32 v226, v226
    v_exp_f32 v227, v227
    v_cvt_pk_bf16_f32 v240, v224, v225
    v_cvt_pk_bf16_f32 v241, v226, v227
    v_mfma_f32_32x32x16_bf16 v[208:223], v[148:151], v[52:55], v[208:223]
    v_exp_f32 v228, v228
    v_exp_f32 v229, v229
    v_exp_f32 v230, v230
    v_exp_f32 v231, v231
    v_cvt_pk_bf16_f32 v242, v228, v229
    v_cvt_pk_bf16_f32 v243, v230, v231
    v_mfma_f32_32x32x16_bf16 v[64:79], v[156:159], v[244:247], v[64:79]
    v_exp_f32 v232, v232
    v_exp_f32 v233, v233
    v_exp_f32 v234, v234
    v_exp_f32 v235, v235
    v_cvt_pk_bf16_f32 v244, v232, v233
    v_cvt_pk_bf16_f32 v245, v234, v235
    v_mfma_f32_32x32x16_bf16 v[80:95], v[152:155], v[240:243], v[80:95]
    v_exp_f32 v236, v236
    v_exp_f32 v237, v237
    v_exp_f32 v238, v238
    v_exp_f32 v239, v239
    v_cvt_pk_bf16_f32 v246, v236, v237
    v_cvt_pk_bf16_f32 v247, v238, v239
    v_mfma_f32_32x32x16_bf16 v[224:239], v[144:147], v[56:59], 0
    v_exp_f32 v208, v208
    v_exp_f32 v209, v209
    v_exp_f32 v210, v210
    v_exp_f32 v211, v211
    v_cvt_pk_bf16_f32 v240, v208, v209
    v_cvt_pk_bf16_f32 v241, v210, v211
    v_mfma_f32_32x32x16_bf16 v[224:239], v[148:151], v[60:63], v[224:239]
    v_exp_f32 v212, v212
    v_exp_f32 v213, v213
    v_exp_f32 v214, v214
    v_exp_f32 v215, v215
    v_cvt_pk_bf16_f32 v242, v212, v213
    v_cvt_pk_bf16_f32 v243, v214, v215
    v_mfma_f32_32x32x16_bf16 v[80:95], v[156:159], v[244:247], v[80:95]
    v_exp_f32 v216, v216
    v_exp_f32 v217, v217
    v_exp_f32 v218, v218
    v_exp_f32 v219, v219
    v_cvt_pk_bf16_f32 v244, v216, v217
    v_cvt_pk_bf16_f32 v245, v218, v219
    v_mfma_f32_32x32x16_bf16 v[96:111], v[152:155], v[240:243], v[96:111]
    v_exp_f32 v220, v220
    v_exp_f32 v221, v221
    v_exp_f32 v222, v222
    v_exp_f32 v223, v223
    v_cvt_pk_bf16_f32 v246, v220, v221
    v_cvt_pk_bf16_f32 v247, v222, v223
    s_waitcnt vmcnt(10)
    v_mfma_f32_32x32x16_bf16 v[208:223], v[160:163], v[32:35], 0
    v_exp_f32 v224, v224
    v_exp_f32 v225, v225
    v_exp_f32 v226, v226
    v_exp_f32 v227, v227
    v_cvt_pk_bf16_f32 v240, v224, v225
    v_cvt_pk_bf16_f32 v241, v226, v227
    v_mfma_f32_32x32x16_bf16 v[208:223], v[164:167], v[36:39], v[208:223]
    v_exp_f32 v228, v228
    v_exp_f32 v229, v229
    v_exp_f32 v230, v230
    v_exp_f32 v231, v231
    v_cvt_pk_bf16_f32 v242, v228, v229
    v_cvt_pk_bf16_f32 v243, v230, v231
    v_mfma_f32_32x32x16_bf16 v[96:111], v[156:159], v[244:247], v[96:111]
    v_exp_f32 v232, v232
    v_exp_f32 v233, v233
    v_exp_f32 v234, v234
    v_exp_f32 v235, v235
    v_cvt_pk_bf16_f32 v244, v232, v233
    v_cvt_pk_bf16_f32 v245, v234, v235
    v_mfma_f32_32x32x16_bf16 v[112:127], v[152:155], v[240:243], v[112:127]
    v_exp_f32 v236, v236
    v_exp_f32 v237, v237
    v_exp_f32 v238, v238
    v_exp_f32 v239, v239
    v_cvt_pk_bf16_f32 v246, v236, v237
    v_cvt_pk_bf16_f32 v247, v238, v239
    v_mfma_f32_32x32x16_bf16 v[224:239], v[160:163], v[40:43], 0
    v_exp_f32 v208, v208
    v_exp_f32 v209, v209
    v_exp_f32 v210, v210
    v_exp_f32 v211, v211
    v_cvt_pk_bf16_f32 v240, v208, v209
    v_cvt_pk_bf16_f32 v241, v210, v211
    v_mfma_f32_32x32x16_bf16 v[224:239], v[164:167], v[44:47], v[224:239]
    v_exp_f32 v212, v212
    v_exp_f32 v213, v213
    v_exp_f32 v214, v214
    v_exp_f32 v215, v215
    v_cvt_pk_bf16_f32 v242, v212, v213
    v_cvt_pk_bf16_f32 v243, v214, v215
    v_mfma_f32_32x32x16_bf16 v[112:127], v[156:159], v[244:247], v[112:127]
    s_setprio 3
    buffer_load_dwordx4 v[144:147], v10, s[48:51], s99 offen offset:0 sc1
    buffer_load_dwordx4 v[148:151], v10, s[48:51], s99 offen offset:1024 sc1
    buffer_load_dwordx4 v[152:155], v10, s[48:51], s99 offen offset:2048 sc1
    buffer_load_dwordx4 v[156:159], v10, s[48:51], s99 offen offset:3072 sc1
    s_setprio 1
    s_add_u32 s99, s99, 4096
    s_and_b32 s99, s99, 0xffff
    v_exp_f32 v216, v216
    v_exp_f32 v217, v217
    v_exp_f32 v218, v218
    v_exp_f32 v219, v219
    v_cvt_pk_bf16_f32 v244, v216, v217
    v_cvt_pk_bf16_f32 v245, v218, v219
    s_waitcnt vmcnt(12)
    v_mfma_f32_32x32x16_bf16 v[64:79], v[168:171], v[240:243], v[64:79]
    v_exp_f32 v220, v220
    v_exp_f32 v221, v221
    v_exp_f32 v222, v222
    v_exp_f32 v223, v223
    v_cvt_pk_bf16_f32 v246, v220, v221
    v_cvt_pk_bf16_f32 v247, v222, v223
    v_mfma_f32_32x32x16_bf16 v[208:223], v[160:163], v[48:51], 0
    v_exp_f32 v224, v224
    v_exp_f32 v225, v225
    v_exp_f32 v226, v226
    v_exp_f32 v227, v227
    v_cvt_pk_bf16_f32 v240, v224, v225
    v_cvt_pk_bf16_f32 v241, v226, v227
    v_mfma_f32_32x32x16_bf16 v[208:223], v[164:167], v[52:55], v[208:223]
    v_exp_f32 v228, v228
    v_exp_f32 v229, v229
    v_exp_f32 v230, v230
    v_exp_f32 v231, v231
    v_cvt_pk_bf16_f32 v242, v228, v229
    v_cvt_pk_bf16_f32 v243, v230, v231
    v_mfma_f32_32x32x16_bf16 v[64:79], v[172:175], v[244:247], v[64:79]
    v_exp_f32 v232, v232
    v_exp_f32 v233, v233
    v_exp_f32 v234, v234
    v_exp_f32 v235, v235
    v_cvt_pk_bf16_f32 v244, v232, v233
    v_cvt_pk_bf16_f32 v245, v234, v235
    v_mfma_f32_32x32x16_bf16 v[80:95], v[168:171], v[240:243], v[80:95]
    v_exp_f32 v236, v236
    v_exp_f32 v237, v237
    v_exp_f32 v238, v238
    v_exp_f32 v239, v239
    v_cvt_pk_bf16_f32 v246, v236, v237
    v_cvt_pk_bf16_f32 v247, v238, v239
    v_mfma_f32_32x32x16_bf16 v[224:239], v[160:163], v[56:59], 0
    v_exp_f32 v208, v208
    v_exp_f32 v209, v209
    v_exp_f32 v210, v210
    v_exp_f32 v211, v211
    v_cvt_pk_bf16_f32 v240, v208, v209
    v_cvt_pk_bf16_f32 v241, v210, v211
    v_mfma_f32_32x32x16_bf16 v[224:239], v[164:167], v[60:63], v[224:239]
    v_exp_f32 v212, v212
    v_exp_f32 v213, v213
    v_exp_f32 v214, v214
    v_exp_f32 v215, v215
    v_cvt_pk_bf16_f32 v242, v212, v213
    v_cvt_pk_bf16_f32 v243, v214, v215
    v_mfma_f32_32x32x16_bf16 v[80:95], v[172:175], v[244:247], v[80:95]
    v_exp_f32 v216, v216
    v_exp_f32 v217, v217
    v_exp_f32 v218, v218
    v_exp_f32 v219, v219
    v_cvt_pk_bf16_f32 v244, v216, v217
    v_cvt_pk_bf16_f32 v245, v218, v219
    v_mfma_f32_32x32x16_bf16 v[96:111], v[168:171], v[240:243], v[96:111]
    v_exp_f32 v220, v220
    v_exp_f32 v221, v221
    v_exp_f32 v222, v222
    v_exp_f32 v223, v223
    v_cvt_pk_bf16_f32 v246, v220, v221
    v_cvt_pk_bf16_f32 v247, v222, v223
    s_waitcnt vmcnt(10)
    v_mfma_f32_32x32x16_bf16 v[208:223], v[176:179], v[32:35], 0
    v_exp_f32 v224, v224
    v_exp_f32 v225, v225
    v_exp_f32 v226, v226
    v_exp_f32 v227, v227
    v_cvt_pk_bf16_f32 v240, v224, v225
    v_cvt_pk_bf16_f32 v241, v226, v227
    v_mfma_f32_32x32x16_bf16 v[208:223], v[180:183], v[36:39], v[208:223]
    v_exp_f32 v228, v228
    v_exp_f32 v229, v229
    v_exp_f32 v230, v230
    v_exp_f32 v231, v231
    v_cvt_pk_bf16_f32 v242, v228, v229
    v_cvt_pk_bf16_f32 v243, v230, v231
    v_mfma_f32_32x32x16_bf16 v[96:111], v[172:175], v[244:247], v[96:111]
    v_exp_f32 v232, v232
    v_exp_f32 v233, v233
    v_exp_f32 v234, v234
    v_exp_f32 v235, v235
    v_cvt_pk_bf16_f32 v244, v232, v233
    v_cvt_pk_bf16_f32 v245, v234, v235
    v_mfma_f32_32x32x16_bf16 v[112:127], v[168:171], v[240:243], v[112:127]
    v_exp_f32 v236, v236
    v_exp_f32 v237, v237
    v_exp_f32 v238, v238
    v_exp_f32 v239, v239
    v_cvt_pk_bf16_f32 v246, v236, v237
    v_cvt_pk_bf16_f32 v247, v238, v239
    v_mfma_f32_32x32x16_bf16 v[224:239], v[176:179], v[40:43], 0
    v_exp_f32 v208, v208
    v_exp_f32 v209, v209
    v_exp_f32 v210, v210
    v_exp_f32 v211, v211
    v_cvt_pk_bf16_f32 v240, v208, v209
    v_cvt_pk_bf16_f32 v241, v210, v211
    v_mfma_f32_32x32x16_bf16 v[224:239], v[180:183], v[44:47], v[224:239]
    v_exp_f32 v212, v212
    v_exp_f32 v213, v213
    v_exp_f32 v214, v214
    v_exp_f32 v215, v215
    v_cvt_pk_bf16_f32 v242, v212, v213
    v_cvt_pk_bf16_f32 v243, v214, v215
    v_mfma_f32_32x32x16_bf16 v[112:127], v[172:175], v[244:247], v[112:127]
    s_setprio 3
    buffer_load_dwordx4 v[160:163], v10, s[48:51], s99 offen offset:0 sc1
    buffer_load_dwordx4 v[164:167], v10, s[48:51], s99 offen offset:1024 sc1
    buffer_load_dwordx4 v[168:171], v10, s[48:51], s99 offen offset:2048 sc1
    buffer_load_dwordx4 v[172:175], v10, s[48:51], s99 offen offset:3072 sc1
    s_setprio 1
    s_add_u32 s99, s99, 4096
    s_and_b32 s99, s99, 0xffff
    v_exp_f32 v216, v216
    v_exp_f32 v217, v217
    v_exp_f32 v218, v218
    v_exp_f32 v219, v219
    v_cvt_pk_bf16_f32 v244, v216, v217
    v_cvt_pk_bf16_f32 v245, v218, v219
    s_waitcnt vmcnt(12)
    v_mfma_f32_32x32x16_bf16 v[64:79], v[184:187], v[240:243], v[64:79]
    v_exp_f32 v220, v220
    v_exp_f32 v221, v221
    v_exp_f32 v222, v222
    v_exp_f32 v223, v223
    v_cvt_pk_bf16_f32 v246, v220, v221
    v_cvt_pk_bf16_f32 v247, v222, v223
    v_mfma_f32_32x32x16_bf16 v[208:223], v[176:179], v[48:51], 0
    v_exp_f32 v224, v224
    v_exp_f32 v225, v225
    v_exp_f32 v226, v226
    v_exp_f32 v227, v227
    v_cvt_pk_bf16_f32 v240, v224, v225
    v_cvt_pk_bf16_f32 v241, v226, v227
    v_mfma_f32_32x32x16_bf16 v[208:223], v[180:183], v[52:55], v[208:223]
    v_exp_f32 v228, v228
    v_exp_f32 v229, v229
    v_exp_f32 v230, v230
    v_exp_f32 v231, v231
    v_cvt_pk_bf16_f32 v242, v228, v229
    v_cvt_pk_bf16_f32 v243, v230, v231
    v_mfma_f32_32x32x16_bf16 v[64:79], v[188:191], v[244:247], v[64:79]
    v_exp_f32 v232, v232
    v_exp_f32 v233, v233
    v_exp_f32 v234, v234
    v_exp_f32 v235, v235
    v_cvt_pk_bf16_f32 v244, v232, v233
    v_cvt_pk_bf16_f32 v245, v234, v235
    v_mfma_f32_32x32x16_bf16 v[80:95], v[184:187], v[240:243], v[80:95]
    v_exp_f32 v236, v236
    v_exp_f32 v237, v237
    v_exp_f32 v238, v238
    v_exp_f32 v239, v239
    v_cvt_pk_bf16_f32 v246, v236, v237
    v_cvt_pk_bf16_f32 v247, v238, v239
    v_mfma_f32_32x32x16_bf16 v[224:239], v[176:179], v[56:59], 0
    v_exp_f32 v208, v208
    v_exp_f32 v209, v209
    v_exp_f32 v210, v210
    v_exp_f32 v211, v211
    v_cvt_pk_bf16_f32 v240, v208, v209
    v_cvt_pk_bf16_f32 v241, v210, v211
    v_mfma_f32_32x32x16_bf16 v[224:239], v[180:183], v[60:63], v[224:239]
    v_exp_f32 v212, v212
    v_exp_f32 v213, v213
    v_exp_f32 v214, v214
    v_exp_f32 v215, v215
    v_cvt_pk_bf16_f32 v242, v212, v213
    v_cvt_pk_bf16_f32 v243, v214, v215
    v_mfma_f32_32x32x16_bf16 v[80:95], v[188:191], v[244:247], v[80:95]
    v_exp_f32 v216, v216
    v_exp_f32 v217, v217
    v_exp_f32 v218, v218
    v_exp_f32 v219, v219
    v_cvt_pk_bf16_f32 v244, v216, v217
    v_cvt_pk_bf16_f32 v245, v218, v219
    v_mfma_f32_32x32x16_bf16 v[96:111], v[184:187], v[240:243], v[96:111]
    v_exp_f32 v220, v220
    v_exp_f32 v221, v221
    v_exp_f32 v222, v222
    v_exp_f32 v223, v223
    v_cvt_pk_bf16_f32 v246, v220, v221
    v_cvt_pk_bf16_f32 v247, v222, v223
    s_waitcnt vmcnt(10)
    v_mfma_f32_32x32x16_bf16 v[208:223], v[128:131], v[32:35], 0
    v_exp_f32 v224, v224
    v_exp_f32 v225, v225
    v_exp_f32 v226, v226
    v_exp_f32 v227, v227
    v_cvt_pk_bf16_f32 v240, v224, v225
    v_cvt_pk_bf16_f32 v241, v226, v227
    v_mfma_f32_32x32x16_bf16 v[208:223], v[132:135], v[36:39], v[208:223]
    v_exp_f32 v228, v228
    v_exp_f32 v229, v229
    v_exp_f32 v230, v230
    v_exp_f32 v231, v231
    v_cvt_pk_bf16_f32 v242, v228, v229
    v_cvt_pk_bf16_f32 v243, v230, v231
    v_mfma_f32_32x32x16_bf16 v[96:111], v[188:191], v[244:247], v[96:111]
    v_exp_f32 v232, v232
    v_exp_f32 v233, v233
    v_exp_f32 v234, v234
    v_exp_f32 v235, v235
    v_cvt_pk_bf16_f32 v244, v232, v233
    v_cvt_pk_bf16_f32 v245, v234, v235
    v_mfma_f32_32x32x16_bf16 v[112:127], v[184:187], v[240:243], v[112:127]
    v_exp_f32 v236, v236
    v_exp_f32 v237, v237
    v_exp_f32 v238, v238
    v_exp_f32 v239, v239
    v_cvt_pk_bf16_f32 v246, v236, v237
    v_cvt_pk_bf16_f32 v247, v238, v239
    s_sub_u32 s12, s12, 1
    s_cmp_lg_u32 s12, 0
    s_cbranch_scc1 L_attloop
L_att_skip:
    ds_read_b32 v22, v20 offset:8228
    v_mfma_f32_32x32x16_bf16 v[112:127], v[188:191], v[244:247], v[112:127]
    s_setprio 3
    s_mov_b32 s8, 0x53800000
    s_mov_b32 s9, 0x2b800000
    s_mov_b32 exec_lo, 0
    s_mov_b64 s[10:11], 0
    v_cmp_nge_f32 vcc, s8, v76
    s_or_b64 s[10:11], s[10:11], vcc
    v_cmp_nle_f32 vcc, s9, v76
    s_or_b64 s[10:11], s[10:11], vcc
    v_cmp_nge_f32 vcc, s8, v92
    s_or_b64 s[10:11], s[10:11], vcc
    v_cmp_nle_f32 vcc, s9, v92
    s_or_b64 s[10:11], s[10:11], vcc
    v_cmp_nge_f32 vcc, s8, v108
    s_or_b64 s[10:11], s[10:11], vcc
    v_cmp_nle_f32 vcc, s9, v108
    s_or_b64 s[10:11], s[10:11], vcc
    s_nop 1
    v_cmp_nge_f32 vcc, s8, v124
    s_or_b64 s[10:11], s[10:11], vcc
    v_cmp_nle_f32 vcc, s9, v124
    s_or_b64 s[10:11], s[10:11], vcc
    s_mov_b64 exec, -1
    s_cmp_eq_u64 s[10:11], 0
    s_cbranch_scc0 L_fallback
L_attok:
    s_waitcnt lgkmcnt(0)
    v_readfirstlane_b32 s13, v22
    s_nop 1
    s_cmp_ge_u32 s13, 4
    s_cbranch_scc1 L_xok
    s_mov_b32 s14, 0
L_ls_25:
    ds_read_b32 v22, v20 offset:8228
    s_add_u32 s14, s14, 1
    s_waitcnt lgkmcnt(0)
    v_readfirstlane_b32 s13, v22
    s_cmp_gt_u32 s14, 1600000
    s_cbranch_scc1 L_lsd_26
    s_cmp_ge_u32 s13, 4
    s_cbranch_scc1 L_lsd_26
    s_branch L_ls_25
L_lsd_26:
L_xok:
    ds_write_b128 v8, v[80:83] offset:0
    ds_write_b128 v8, v[84:87] offset:1024
    ds_write_b128 v8, v[88:91] offset:2048
    ds_write_b128 v8, v[92:95] offset:3072
    ds_write_b128 v8, v[96:99] offset:4096
    ds_write_b128 v8, v[100:103] offset:5120
    ds_write_b128 v8, v[104:107] offset:6144
    ds_write_b128 v8, v[108:111] offset:7168
    ds_write_b128 v5, v[112:115] offset:0
    ds_write_b128 v5, v[116:119] offset:1024
    ds_write_b128 v5, v[120:123] offset:2048
    ds_write_b128 v5, v[124:127] offset:3072
    s_cmp_eq_u32 s100, 0
    s_cbranch_scc1 L_nom
    s_mov_b64 exec, 1
    ds_add_u32 v20, v21 offset:8268
    s_mov_b64 exec, -1
L_nom:
    ds_write_b32 v16, v13 offset:256
    ds_write_b32 v17, v14 offset:512
    ds_write_b32 v18, v15 offset:768
    s_mov_b64 exec, 1
    ds_add_u32 v20, v21 offset:8208
    s_mov_b64 exec, -1
    s_mov_b32 s14, 0
L_ls_27:
    ds_read_b32 v22, v20 offset:8208
    s_add_u32 s14, s14, 1
    s_waitcnt lgkmcnt(0)
    v_readfirstlane_b32 s13, v22
    s_cmp_gt_u32 s14, 1600000
    s_cbranch_scc1 L_lsd_28
    s_cmp_ge_u32 s13, 4
    s_cbranch_scc1 L_lsd_28
    s_branch L_ls_27
L_lsd_28:
    ds_read_b32 v22, v20 offset:8268
    ds_read_b128 v[80:83], v2 offset:0
    ds_read_b128 v[84:87], v2 offset:1024
    ds_read_b128 v[88:91], v2 offset:2048
    ds_read_b128 v[92:95], v2 offset:3072
    ds_read_b128 v[96:99], v3 offset:0
    ds_read_b128 v[100:103], v3 offset:1024
    ds_read_b128 v[104:107], v3 offset:2048
    ds_read_b128 v[108:111], v3 offset:3072
    ds_read_b128 v[112:115], v4 offset:0
    ds_read_b128 v[116:119], v4 offset:1024
    ds_read_b128 v[120:123], v4 offset:2048
    ds_read_b128 v[124:127], v4 offset:3072
    s_waitcnt lgkmcnt(12)
    v_readfirstlane_b32 s13, v22
    s_nop 1
    s_cmp_lg_u32 s13, 0
    s_cbranch_scc1 L_scaled
    s_waitcnt lgkmcnt(8)
    v_pk_add_f32 v[64:65], v[64:65], v[80:81]
    v_pk_add_f32 v[66:67], v[66:67], v[82:83]
    v_pk_add_f32 v[68:69], v[68:69], v[84:85]
    v_pk_add_f32 v[70:71], v[70:71], v[86:87]
    v_pk_add_f32 v[72:73], v[72:73], v[88:89]
    v_pk_add_f32 v[74:75], v[74:75], v[90:91]
    v_pk_add_f32 v[76:77], v[76:77], v[92:93]
    v_pk_add_f32 v[78:79], v[78:79], v[94:95]
    s_waitcnt lgkmcnt(4)
    v_pk_add_f32 v[64:65], v[64:65], v[96:97]
    v_pk_add_f32 v[66:67], v[66:67], v[98:99]
    v_pk_add_f32 v[68:69], v[68:69], v[100:101]
    v_pk_add_f32 v[70:71], v[70:71], v[102:103]
    v_pk_add_f32 v[72:73], v[72:73], v[104:105]
    v_pk_add_f32 v[74:75], v[74:75], v[106:107]
    v_pk_add_f32 v[76:77], v[76:77], v[108:109]
    v_pk_add_f32 v[78:79], v[78:79], v[110:111]
    s_waitcnt lgkmcnt(0)
    v_pk_add_f32 v[64:65], v[64:65], v[112:113]
    v_pk_add_f32 v[66:67], v[66:67], v[114:115]
    v_pk_add_f32 v[68:69], v[68:69], v[116:117]
    v_pk_add_f32 v[70:71], v[70:71], v[118:119]
    v_pk_add_f32 v[72:73], v[72:73], v[120:121]
    v_pk_add_f32 v[74:75], v[74:75], v[122:123]
    v_pk_add_f32 v[76:77], v[76:77], v[124:125]
    v_pk_add_f32 v[78:79], v[78:79], v[126:127]
L_summed:
    v_mov_b32 v25, v76
    v_mov_b32 v24, v76
    s_nop 1
    v_permlane32_swap_b32 v25, v24
    s_nop 1
    v_rcp_f32 v24, v24
    s_nop 0
    v_pk_mul_f32 v[64:65], v[64:65], v[24:25] op_sel_hi:[1,0]
    v_pk_mul_f32 v[66:67], v[66:67], v[24:25] op_sel_hi:[1,0]
    v_pk_mul_f32 v[68:69], v[68:69], v[24:25] op_sel_hi:[1,0]
    v_pk_mul_f32 v[70:71], v[70:71], v[24:25] op_sel_hi:[1,0]
    v_pk_mul_f32 v[72:73], v[72:73], v[24:25] op_sel_hi:[1,0]
    v_pk_mul_f32 v[74:75], v[74:75], v[24:25] op_sel_hi:[1,0]
    v_pk_mul_f32 v[76:77], v[76:77], v[24:25] op_sel_hi:[1,0]
    v_pk_mul_f32 v[78:79], v[78:79], v[24:25] op_sel_hi:[1,0]
    v_cvt_pk_bf16_f32 v240, v64, v65
    v_cvt_pk_bf16_f32 v241, v66, v67
    v_cvt_pk_bf16_f32 v242, v68, v69
    v_cvt_pk_bf16_f32 v243, v70, v71
    buffer_store_dwordx4 v[240:243], v23, s[84:87], s16 offen sc1
    v_cvt_pk_bf16_f32 v244, v72, v73
    v_cvt_pk_bf16_f32 v245, v74, v75
    v_cvt_pk_bf16_f32 v246, v76, v77
    v_cvt_pk_bf16_f32 v247, v78, v79
    s_mov_b32 exec_lo, 0
    v_mov_b32 v246, 0
    v_mov_b32 v247, 0
    s_mov_b64 exec, -1
    buffer_store_dwordx4 v[244:247], v23, s[84:87], s16 offen offset:2048 sc1
    s_waitcnt vmcnt(0)
    s_atomic_add s26, s[84:85], s17
    s_branch L_end
L_scaled:
    ds_read_b32 v13, v9 offset:256
    ds_read_b32 v14, v9 offset:512
    ds_read_b32 v15, v9 offset:768
    s_waitcnt lgkmcnt(0)
    v_max3_f32 v24, v12, v13, v14
    v_max_f32 v24, v24, v15
    v_sub_f32 v12, v12, v24
    v_sub_f32 v13, v13, v24
    v_sub_f32 v14, v14, v24
    v_sub_f32 v15, v15, v24
    v_exp_f32 v12, v12
    v_exp_f32 v13, v13
    v_exp_f32 v14, v14
    v_exp_f32 v15, v15
    s_nop 0
    v_mul_f32 v64, v64, v12
    v_mul_f32 v65, v65, v12
    v_mul_f32 v66, v66, v12
    v_mul_f32 v67, v67, v12
    v_mul_f32 v68, v68, v12
    v_mul_f32 v69, v69, v12
    v_mul_f32 v70, v70, v12
    v_mul_f32 v71, v71, v12
    v_mul_f32 v72, v72, v12
    v_mul_f32 v73, v73, v12
    v_mul_f32 v74, v74, v12
    v_mul_f32 v75, v75, v12
    v_mul_f32 v76, v76, v12
    v_mul_f32 v77, v77, v12
    v_mul_f32 v78, v78, v12
    v_mul_f32 v79, v79, v12
    v_fmac_f32 v64, v80, v13
    v_fmac_f32 v65, v81, v13
    v_fmac_f32 v66, v82, v13
    v_fmac_f32 v67, v83, v13
    v_fmac_f32 v68, v84, v13
    v_fmac_f32 v69, v85, v13
    v_fmac_f32 v70, v86, v13
    v_fmac_f32 v71, v87, v13
    v_fmac_f32 v72, v88, v13
    v_fmac_f32 v73, v89, v13
    v_fmac_f32 v74, v90, v13
    v_fmac_f32 v75, v91, v13
    v_fmac_f32 v76, v92, v13
    v_fmac_f32 v77, v93, v13
    v_fmac_f32 v78, v94, v13
    v_fmac_f32 v79, v95, v13
    v_fmac_f32 v64, v96, v14
    v_fmac_f32 v65, v97, v14
    v_fmac_f32 v66, v98, v14
    v_fmac_f32 v67, v99, v14
    v_fmac_f32 v68, v100, v14
    v_fmac_f32 v69, v101, v14
    v_fmac_f32 v70, v102, v14
    v_fmac_f32 v71, v103, v14
    v_fmac_f32 v72, v104, v14
    v_fmac_f32 v73, v105, v14
    v_fmac_f32 v74, v106, v14
    v_fmac_f32 v75, v107, v14
    v_fmac_f32 v76, v108, v14
    v_fmac_f32 v77, v109, v14
    v_fmac_f32 v78, v110, v14
    v_fmac_f32 v79, v111, v14
    v_fmac_f32 v64, v112, v15
    v_fmac_f32 v65, v113, v15
    v_fmac_f32 v66, v114, v15
    v_fmac_f32 v67, v115, v15
    v_fmac_f32 v68, v116, v15
    v_fmac_f32 v69, v117, v15
    v_fmac_f32 v70, v118, v15
    v_fmac_f32 v71, v119, v15
    v_fmac_f32 v72, v120, v15
    v_fmac_f32 v73, v121, v15
    v_fmac_f32 v74, v122, v15
    v_fmac_f32 v75, v123, v15
    v_fmac_f32 v76, v124, v15
    v_fmac_f32 v77, v125, v15
    v_fmac_f32 v78, v126, v15
    v_fmac_f32 v79, v127, v15
    s_branch L_summed
L_fallback:
    s_cmp_lg_u32 s100, 0
    s_cbranch_scc1 L_attok
    s_mov_b32 s100, 1
    s_mov_b32 s99, 0
    s_mov_b32 s50, 0x40000
    s_mov_b32 s12, 16
    s_waitcnt vmcnt(0)
    v_mov_b32 v12, 0xff800000
    v_mov_b32 v13, 0xff800000
    v_mov_b32 v14, 0xff800000
    v_mov_b32 v15, 0xff800000
L_mx:
    buffer_load_dwordx4 v[128:131], v10, s[48:51], s99 offen sc1
    buffer_load_dwordx4 v[132:135], v10, s[48:51], s99 offen offset:1024 sc1
    s_add_u32 s99, s99, 4096
    s_waitcnt vmcnt(0)
    v_mfma_f32_32x32x16_bf16 v[208:223], v[128:131], v[32:35], 0
    v_mfma_f32_32x32x16_bf16 v[208:223], v[132:135], v[36:39], v[208:223]
    s_nop 15
    v_max3_f32 v12, v208, v209, v12
    v_max3_f32 v12, v210, v211, v12
    v_max3_f32 v12, v212, v213, v12
    v_max3_f32 v12, v214, v215, v12
    v_max3_f32 v12, v216, v217, v12
    v_max3_f32 v12, v218, v219, v12
    v_max3_f32 v12, v220, v221, v12
    v_max3_f32 v12, v222, v223, v12
    v_mfma_f32_32x32x16_bf16 v[208:223], v[128:131], v[40:43], 0
    v_mfma_f32_32x32x16_bf16 v[208:223], v[132:135], v[44:47], v[208:223]
    s_nop 15
    v_max3_f32 v13, v208, v209, v13
    v_max3_f32 v13, v210, v211, v13
    v_max3_f32 v13, v212, v213, v13
    v_max3_f32 v13, v214, v215, v13
    v_max3_f32 v13, v216, v217, v13
    v_max3_f32 v13, v218, v219, v13
    v_max3_f32 v13, v220, v221, v13
    v_max3_f32 v13, v222, v223, v13
    v_mfma_f32_32x32x16_bf16 v[208:223], v[128:131], v[48:51], 0
    v_mfma_f32_32x32x16_bf16 v[208:223], v[132:135], v[52:55], v[208:223]
    s_nop 15
    v_max3_f32 v14, v208, v209, v14
    v_max3_f32 v14, v210, v211, v14
    v_max3_f32 v14, v212, v213, v14
    v_max3_f32 v14, v214, v215, v14
    v_max3_f32 v14, v216, v217, v14
    v_max3_f32 v14, v218, v219, v14
    v_max3_f32 v14, v220, v221, v14
    v_max3_f32 v14, v222, v223, v14
    v_mfma_f32_32x32x16_bf16 v[208:223], v[128:131], v[56:59], 0
    v_mfma_f32_32x32x16_bf16 v[208:223], v[132:135], v[60:63], v[208:223]
    s_nop 15
    v_max3_f32 v15, v208, v209, v15
    v_max3_f32 v15, v210, v211, v15
    v_max3_f32 v15, v212, v213, v15
    v_max3_f32 v15, v214, v215, v15
    v_max3_f32 v15, v216, v217, v15
    v_max3_f32 v15, v218, v219, v15
    v_max3_f32 v15, v220, v221, v15
    v_max3_f32 v15, v222, v223, v15
    s_sub_u32 s12, s12, 1
    s_cmp_lg_u32 s12, 0
    s_cbranch_scc1 L_mx
    v_mov_b32 v24, v12
    v_mov_b32 v25, v12
    s_nop 1
    v_permlane32_swap_b32 v24, v25
    s_nop 1
    v_max_f32 v12, v24, v25
    v_xor_b32 v24, 0x80000000, v12
    v_and_b32 v25, 0xffff0000, v24
    v_sub_f32 v24, v24, v25
    v_and_b32 v26, 0xffff0000, v24
    v_sub_f32 v24, v24, v26
    v_lshrrev_b32 v25, 16, v25
    s_mov_b32 exec_lo, 0
    v_or_b32 v38, v25, v26
    v_lshrrev_b32 v39, 16, v24
    s_mov_b64 exec, -1
    v_mov_b32 v24, v13
    v_mov_b32 v25, v13
    s_nop 1
    v_permlane32_swap_b32 v24, v25
    s_nop 1
    v_max_f32 v13, v24, v25
    v_xor_b32 v24, 0x80000000, v13
    v_and_b32 v25, 0xffff0000, v24
    v_sub_f32 v24, v24, v25
    v_and_b32 v26, 0xffff0000, v24
    v_sub_f32 v24, v24, v26
    v_lshrrev_b32 v25, 16, v25
    s_mov_b32 exec_lo, 0
    v_or_b32 v46, v25, v26
    v_lshrrev_b32 v47, 16, v24
    s_mov_b64 exec, -1
    v_mov_b32 v24, v14
    v_mov_b32 v25, v14
    s_nop 1
    v_permlane32_swap_b32 v24, v25
    s_nop 1
    v_max_f32 v14, v24, v25
    v_xor_b32 v24, 0x80000000, v14
    v_and_b32 v25, 0xffff0000, v24
    v_sub_f32 v24, v24, v25
    v_and_b32 v26, 0xffff0000, v24
    v_sub_f32 v24, v24, v26
    v_lshrrev_b32 v25, 16, v25
    s_mov_b32 exec_lo, 0
    v_or_b32 v54, v25, v26
    v_lshrrev_b32 v55, 16, v24
    s_mov_b64 exec, -1
    v_mov_b32 v24, v15
    v_mov_b32 v25, v15
    s_nop 1
    v_permlane32_swap_b32 v24, v25
    s_nop 1
    v_max_f32 v15, v24, v25
    v_xor_b32 v24, 0x80000000, v15
    v_and_b32 v25, 0xffff0000, v24
    v_sub_f32 v24, v24, v25
    v_and_b32 v26, 0xffff0000, v24
    v_sub_f32 v24, v24, v26
    v_lshrrev_b32 v25, 16, v25
    s_mov_b32 exec_lo, 0
    v_or_b32 v62, v25, v26
    v_lshrrev_b32 v63, 16, v24
    s_mov_b64 exec, -1
    s_branch L_att_restart
L_G2:
    s_cmp_eq_u32 s96, 0
    s_cbranch_scc1 L_idle1
    s_lshl_b32 s8, s93, 2
    s_add_u32 s8, s8, s92
    s_lshl_b32 s8, s8, 6
    s_cmp_eq_u32 s41, 0
    s_cselect_b32 s8, 0x10000, s8
    v_lshlrev_b32 v24, 3, v18
    buffer_load_dwordx2 v[240:241], v24, s[64:67], s8 offen offset:0
    buffer_load_dwordx2 v[242:243], v24, s[64:67], s8 offen offset:16
    buffer_load_dwordx2 v[244:245], v24, s[64:67], s8 offen offset:32
    buffer_load_dwordx2 v[246:247], v24, s[64:67], s8 offen offset:48
    v_mul_u32_u24 v10, 3584, v14
    v_add_u32 v10, v10, v15
    v_add_u32 v11, 27648, v10
    v_add_u32 v12, 27648, v11
    v_add_u32 v13, 27648, v12
    s_and_b32 s9, s92, 1
    s_lshl_b32 s8, s21, 4
    s_add_u32 s8, s8, s9
    s_mul_i32 s88, s8, 114688
    s_lshl_b32 s8, s93, 1
    s_lshr_b32 s10, s92, 1
    s_add_u32 s8, s8, s10
    s_lshl_b32 s8, s8, 7
    s_add_u32 s88, s88, s8
    s_add_u32 s89, s88, 1835008
    s_mul_i32 s8, s16, 229376
    s_add_u32 s98, s88, s8
    s_lshl_b32 s10, s10, 16
    s_add_u32 s10, s10, 8704
    s_sub_u32 s8, s10, s101
    v_add_u32 v29, s8, v4
    s_lshl_b32 s9, s9, 15
    s_add_u32 s100, s10, s9
    v_add_u32 v0, 8704, v23
    v_add_u32 v19, 74240, v23
    s_lshl_b32 s8, s92, 1
    s_lshr_b32 s8, s22, s8
    s_and_b32 s8, s8, 3
    s_add_u32 s8, s8, s40
    s_lshl_b32 s8, s8, 2
    s_add_u32 s8, s8, s21
    s_lshl_b32 s90, s8, 15
    s_add_u32 s90, s90, 262144
    s_add_u32 s91, s90, 32768
    s_lshl_b32 s8, s16, 12
    s_add_u32 s99, s90, s8
    s_lshr_b32 s15, s94, 1
    s_cmp_eq_u32 s92, 3
    s_cselect_b32 s15, s15, 0
    s_mov_b32 s14, 0
L_ls_29:
    ds_read_b32 v22, v20 offset:8216
    s_add_u32 s14, s14, 1
    s_waitcnt lgkmcnt(0)
    v_readfirstlane_b32 s13, v22
    s_cmp_gt_u32 s14, 1600000
    s_cbranch_scc1 L_lsd_30
    s_cmp_ge_u32 s13, 5
    s_cbranch_scc1 L_lsd_30
    s_branch L_ls_29
L_lsd_30:
    s_lshr_b32 s8, s92, 1
    s_lshl_b32 s8, s8, 13
    s_add_u32 s8, s8, 139776
    s_sub_u32 s8, s8, s101
    v_add_u32 v28, s8, v4
    s_mov_b32 s52, s84
    s_mov_b32 s53, s85
    s_cmp_lg_u32 s15, 0
    s_cselect_b32 s54, 0, s86
    s_mov_b32 s55, 0x20000
    s_lshl_b32 s8, s92, 12
    s_add_u32 m0, s8, 139776
    s_nop 0
    buffer_load_dwordx4 v10, s[60:63], s98 offen offset:0 nt lds
    buffer_load_dwordx4 v11, s[60:63], s98 offen offset:1024 nt lds
    buffer_load_dwordx4 v12, s[60:63], s98 offen offset:2048 nt lds
    buffer_load_dwordx4 v13, s[60:63], s98 offen offset:3072 nt lds
    s_add_u32 s98, s98, 229376
    s_cmp_eq_u32 s98, s89
    s_cselect_b32 s98, s88, s98
    v_and_b32 v26, 31, v1
    v_mul_u32_u24 v26, 3584, v26
    s_mov_b32 exec_hi, 0
    buffer_load_dword v30, v26, s[60:63], s98 offen nt
    s_mov_b64 exec, -1
    s_mov_b32 s14, 0
L_ls_31:
    ds_read_b32 v22, v20 offset:8264
    s_add_u32 s14, s14, 1
    s_waitcnt lgkmcnt(0)
    v_readfirstlane_b32 s13, v22
    s_cmp_gt_u32 s14, 1600000
    s_cbranch_scc1 L_lsd_32
    s_cmp_ge_u32 s13, 4
    s_cbranch_scc1 L_lsd_32
    s_branch L_ls_31
L_lsd_32:
    s_add_u32 m0, s100, 4096
    s_nop 0
    buffer_load_dwordx4 v10, s[60:63], s98 offen offset:0 lds
    buffer_load_dwordx4 v11, s[60:63], s98 offen offset:1024 lds
    buffer_load_dwordx4 v12, s[60:63], s98 offen offset:2048 lds
    buffer_load_dwordx4 v13, s[60:63], s98 offen offset:3072 lds
    s_add_u32 s98, s98, 229376
    s_cmp_eq_u32 s98, s89
    s_cselect_b32 s98, s88, s98
    s_add_u32 m0, s100, 8192
    s_nop 0
    buffer_load_dwordx4 v10, s[60:63], s98 offen offset:0 lds
    buffer_load_dwordx4 v11, s[60:63], s98 offen offset:1024 lds
    buffer_load_dwordx4 v12, s[60:63], s98 offen offset:2048 lds
    buffer_load_dwordx4 v13, s[60:63], s98 offen offset:3072 lds
    s_add_u32 s98, s98, 229376
    s_cmp_eq_u32 s98, s89
    s_cselect_b32 s98, s88, s98
    s_add_u32 m0, s100, 12288
    s_nop 0
    buffer_load_dwordx4 v10, s[60:63], s98 offen offset:0 lds
    buffer_load_dwordx4 v11, s[60:63], s98 offen offset:1024 lds
    buffer_load_dwordx4 v12, s[60:63], s98 offen offset:2048 lds
    buffer_load_dwordx4 v13, s[60:63], s98 offen offset:3072 lds
    s_add_u32 s98, s98, 229376
    s_cmp_eq_u32 s98, s89
    s_cselect_b32 s98, s88, s98
    s_add_u32 m0, s100, 16384
    s_nop 0
    buffer_load_dwordx4 v10, s[60:63], s98 offen offset:0 lds
    buffer_load_dwordx4 v11, s[60:63], s98 offen offset:1024 lds
    buffer_load_dwordx4 v12, s[60:63], s98 offen offset:2048 lds
    buffer_load_dwordx4 v13, s[60:63], s98 offen offset:3072 lds
    s_add_u32 s98, s98, 229376
    s_cmp_eq_u32 s98, s89
    s_cselect_b32 s98, s88, s98
    s_add_u32 m0, s100, 20480
    s_nop 0
    buffer_load_dwordx4 v10, s[60:63], s98 offen offset:0 lds
    buffer_load_dwordx4 v11, s[60:63], s98 offen offset:1024 lds
    buffer_load_dwordx4 v12, s[60:63], s98 offen offset:2048 lds
    buffer_load_dwordx4 v13, s[60:63], s98 offen offset:3072 lds
    s_add_u32 s98, s98, 229376
    s_cmp_eq_u32 s98, s89
    s_cselect_b32 s98, s88, s98
    s_lshl_b32 s12, s2, 10
    s_add_u32 s12, s12, 6291456
    s_load_dword s11, s[84:85], s12 glc
    s_waitcnt vmcnt(25)
    v_lshlrev_b32 v32, 16, v240
    v_and_b32 v33, 0xffff0000, v240
    v_lshlrev_b32 v34, 16, v241
    v_and_b32 v35, 0xffff0000, v241
    v_lshlrev_b32 v36, 16, v242
    v_and_b32 v37, 0xffff0000, v242
    v_lshlrev_b32 v38, 16, v243
    v_and_b32 v39, 0xffff0000, v243
    v_lshlrev_b32 v40, 16, v244
    v_and_b32 v41, 0xffff0000, v244
    v_lshlrev_b32 v42, 16, v245
    v_and_b32 v43, 0xffff0000, v245
    v_lshlrev_b32 v44, 16, v246
    v_and_b32 v45, 0xffff0000, v246
    v_lshlrev_b32 v46, 16, v247
    v_and_b32 v47, 0xffff0000, v247
    s_waitcnt vmcnt(12)
    s_waitcnt lgkmcnt(0)
    s_lshl_b32 s13, s92, 2
    v_mov_b32 v24, 1
    v_mov_b32 v25, s13
    s_mov_b64 exec, 1
    ds_write_b32 v25, v24 offset:8272
    s_mov_b64 exec, -1
    s_mov_b32 s14, 0
L_wp_33:
    ds_read_b128 v[24:27], v20 offset:8272
    s_add_u32 s14, s14, 1
    s_waitcnt lgkmcnt(0)
    v_min_u32 v24, v24, v25
    v_min3_u32 v24, v24, v26, v27
    s_cmp_gt_u32 s14, 1600000
    v_readfirstlane_b32 s13, v24
    s_cbranch_scc1 L_wpd_34
    s_cmp_ge_u32 s13, 1
    s_cbranch_scc0 L_wp_33
L_wpd_34:
    s_waitcnt lgkmcnt(0)
    s_cmp_ge_u32 s11, 1
    s_cbranch_scc1 L_gok
    s_mov_b32 s14, 0
L_sp_35:
    s_load_dword s13, s[84:85], s12 offset:0 glc
    s_add_u32 s14, s14, 1
    s_waitcnt lgkmcnt(0)
    s_cmp_ge_u32 s13, 1
    s_cbranch_scc1 L_spd_36
    s_cmp_gt_u32 s14, 400000
    s_cbranch_scc0 L_sp_35
L_spd_36:
L_gok:
    s_cmp_lt_u32 s94, 2
    s_cselect_b64 vcc, -1, 0
    s_add_u32 m0, s100, 0
    s_nop 0
    buffer_load_dwordx4 v23, s[52:55], s99 offen offset:0 sc1 lds
    buffer_load_dwordx4 v23, s[52:55], s99 offen offset:1024 sc1 lds
    buffer_load_dwordx4 v23, s[52:55], s99 offen offset:2048 sc1 lds
    buffer_load_dwordx4 v23, s[52:55], s99 offen offset:3072 sc1 lds
    s_add_u32 s99, s99, 4096
    s_cmp_eq_u32 s99, s91
    s_cselect_b32 s99, s90, s99
    s_mov_b64 exec, 1
    ds_add_u32 v20, v21 offset:8224
    s_mov_b64 exec, -1
    ds_read_b64_tr_b16 v[96:97], v28 offset:0
    ds_read_b64_tr_b16 v[98:99], v28 offset:1024
    ds_read_b64_tr_b16 v[100:101], v28 offset:2048
    ds_read_b64_tr_b16 v[102:103], v28 offset:3072
    ds_read_b64_tr_b16 v[104:105], v28 offset:4096
    ds_read_b64_tr_b16 v[106:107], v28 offset:5120
    ds_read_b64_tr_b16 v[108:109], v28 offset:6144
    ds_read_b64_tr_b16 v[110:111], v28 offset:7168
    ds_read_b64_tr_b16 v[112:113], v29 offset:4096
    ds_read_b64_tr_b16 v[114:115], v29 offset:5120
    ds_read_b64_tr_b16 v[116:117], v29 offset:6144
    ds_read_b64_tr_b16 v[118:119], v29 offset:7168
    ds_read_b64_tr_b16 v[120:121], v29 offset:36864
    ds_read_b64_tr_b16 v[122:123], v29 offset:37888
    ds_read_b64_tr_b16 v[124:125], v29 offset:38912
    ds_read_b64_tr_b16 v[126:127], v29 offset:39936
    ds_read_b64_tr_b16 v[128:129], v29 offset:8192
    ds_read_b64_tr_b16 v[130:131], v29 offset:9216
    ds_read_b64_tr_b16 v[132:133], v29 offset:10240
    ds_read_b64_tr_b16 v[134:135], v29 offset:11264
    ds_read_b64_tr_b16 v[136:137], v29 offset:40960
    ds_read_b64_tr_b16 v[138:139], v29 offset:41984
    ds_read_b64_tr_b16 v[140:141], v29 offset:43008
    ds_read_b64_tr_b16 v[142:143], v29 offset:44032
    s_add_u32 m0, s100, 24576
    s_nop 0
    buffer_load_dwordx4 v10, s[60:63], s98 offen offset:0 lds
    buffer_load_dwordx4 v11, s[60:63], s98 offen offset:1024 lds
    buffer_load_dwordx4 v12, s[60:63], s98 offen offset:2048 lds
    buffer_load_dwordx4 v13, s[60:63], s98 offen offset:3072 lds
    s_add_u32 s98, s98, 229376
    s_cmp_eq_u32 s98, s89
    s_cselect_b32 s98, s88, s98
    s_add_u32 m0, s100, 28672
    s_nop 0
    buffer_load_dwordx4 v10, s[60:63], s98 offen offset:0 lds
    buffer_load_dwordx4 v11, s[60:63], s98 offen offset:1024 lds
    buffer_load_dwordx4 v12, s[60:63], s98 offen offset:2048 lds
    buffer_load_dwordx4 v13, s[60:63], s98 offen offset:3072 lds
    s_add_u32 s98, s98, 229376
    s_cmp_eq_u32 s98, s89
    s_cselect_b32 s98, s88, s98
    s_waitcnt vmcnt(12)
    s_waitcnt lgkmcnt(0)
    s_lshl_b32 s13, s92, 2
    v_mov_b32 v24, 2
    v_mov_b32 v25, s13
    s_mov_b64 exec, 1
    ds_write_b32 v25, v24 offset:8272
    s_mov_b64 exec, -1
    s_mov_b32 s14, 0
L_wp_37:
    ds_read_b128 v[24:27], v20 offset:8272
    s_add_u32 s14, s14, 1
    s_waitcnt lgkmcnt(0)
    v_min_u32 v24, v24, v25
    v_min3_u32 v24, v24, v26, v27
    s_cmp_gt_u32 s14, 1600000
    v_readfirstlane_b32 s13, v24
    s_cbranch_scc1 L_wpd_38
    s_cmp_ge_u32 s13, 2
    s_cbranch_scc0 L_wp_37
L_wpd_38:
    s_add_u32 m0, s100, 4096
    s_nop 0
    buffer_load_dwordx4 v23, s[52:55], s99 offen offset:0 sc1 lds
    buffer_load_dwordx4 v23, s[52:55], s99 offen offset:1024 sc1 lds
    buffer_load_dwordx4 v23, s[52:55], s99 offen offset:2048 sc1 lds
    buffer_load_dwordx4 v23, s[52:55], s99 offen offset:3072 sc1 lds
    s_add_u32 s99, s99, 4096
    s_cmp_eq_u32 s99, s91
    s_cselect_b32 s99, s90, s99
    s_add_u32 m0, s100, 8192
    s_nop 0
    buffer_load_dwordx4 v23, s[52:55], s99 offen offset:0 sc1 lds
    buffer_load_dwordx4 v23, s[52:55], s99 offen offset:1024 sc1 lds
    buffer_load_dwordx4 v23, s[52:55], s99 offen offset:2048 sc1 lds
    buffer_load_dwordx4 v23, s[52:55], s99 offen offset:3072 sc1 lds
    s_add_u32 s99, s99, 4096
    s_cmp_eq_u32 s99, s91
    s_cselect_b32 s99, s90, s99
    ds_read_b64_tr_b16 v[144:145], v29 offset:12288
    ds_read_b64_tr_b16 v[146:147], v29 offset:13312
    ds_read_b64_tr_b16 v[148:149], v29 offset:14336
    ds_read_b64_tr_b16 v[150:151], v29 offset:15360
    ds_read_b64_tr_b16 v[152:153], v29 offset:45056
    ds_read_b64_tr_b16 v[154:155], v29 offset:46080
    ds_read_b64_tr_b16 v[156:157], v29 offset:47104
    ds_read_b64_tr_b16 v[158:159], v29 offset:48128
    ds_read_b64_tr_b16 v[160:161], v29 offset:16384
    ds_read_b64_tr_b16 v[162:163], v29 offset:17408
    ds_read_b64_tr_b16 v[164:165], v29 offset:18432
    ds_read_b64_tr_b16 v[166:167], v29 offset:19456
    ds_read_b64_tr_b16 v[168:169], v29 offset:49152
    ds_read_b64_tr_b16 v[170:171], v29 offset:50176
    ds_read_b64_tr_b16 v[172:173], v29 offset:51200
    ds_read_b64_tr_b16 v[174:175], v29 offset:52224
    ds_read_b64_tr_b16 v[176:177], v29 offset:20480
    ds_read_b64_tr_b16 v[178:179], v29 offset:21504
    ds_read_b64_tr_b16 v[180:181], v29 offset:22528
    ds_read_b64_tr_b16 v[182:183], v29 offset:23552
    ds_read_b64_tr_b16 v[184:185], v29 offset:53248
    ds_read_b64_tr_b16 v[186:187], v29 offset:54272
    ds_read_b64_tr_b16 v[188:189], v29 offset:55296
    ds_read_b64_tr_b16 v[190:191], v29 offset:56320
    s_waitcnt vmcnt(8)
    s_waitcnt lgkmcnt(0)
    s_lshl_b32 s13, s92, 2
    v_mov_b32 v24, 3
    v_mov_b32 v25, s13
    s_mov_b64 exec, 1
    ds_write_b32 v25, v24 offset:8272
    s_mov_b64 exec, -1
    s_mov_b32 s14, 0
L_wp_39:
    ds_read_b128 v[24:27], v20 offset:8272
    s_add_u32 s14, s14, 1
    s_waitcnt lgkmcnt(0)
    v_min_u32 v24, v24, v25
    v_min3_u32 v24, v24, v26, v27
    s_cmp_gt_u32 s14, 1600000
    v_readfirstlane_b32 s13, v24
    s_cbranch_scc1 L_wpd_40
    s_cmp_ge_u32 s13, 3
    s_cbranch_scc0 L_wp_39
L_wpd_40:
    s_add_u32 m0, s100, 12288
    s_nop 0
    buffer_load_dwordx4 v23, s[52:55], s99 offen offset:0 sc1 lds
    buffer_load_dwordx4 v23, s[52:55], s99 offen offset:1024 sc1 lds
    buffer_load_dwordx4 v23, s[52:55], s99 offen offset:2048 sc1 lds
    buffer_load_dwordx4 v23, s[52:55], s99 offen offset:3072 sc1 lds
    s_add_u32 s99, s99, 4096
    s_cmp_eq_u32 s99, s91
    s_cselect_b32 s99, s90, s99
    ds_read_b64_tr_b16 v[192:193], v29 offset:24576
    ds_read_b64_tr_b16 v[194:195], v29 offset:25600
    ds_read_b64_tr_b16 v[196:197], v29 offset:26624
    ds_read_b64_tr_b16 v[198:199], v29 offset:27648
    ds_read_b64_tr_b16 v[200:201], v29 offset:57344
    ds_read_b64_tr_b16 v[202:203], v29 offset:58368
    ds_read_b64_tr_b16 v[204:205], v29 offset:59392
    ds_read_b64_tr_b16 v[206:207], v29 offset:60416
    ds_read_b64_tr_b16 v[208:209], v29 offset:28672
    ds_read_b64_tr_b16 v[210:211], v29 offset:29696
    ds_read_b64_tr_b16 v[212:213], v29 offset:30720
    ds_read_b64_tr_b16 v[214:215], v29 offset:31744
    ds_read_b64_tr_b16 v[216:217], v29 offset:61440
    ds_read_b64_tr_b16 v[218:219], v29 offset:62464
    ds_read_b64_tr_b16 v[220:221], v29 offset:63488
    ds_read_b64_tr_b16 v[222:223], v29 offset:64512
    ds_read_b128 v[224:227], v0 offset:0
    ds_read_b128 v[228:231], v0 offset:32768
    ds_read_b128 v[232:235], v19 offset:0
    ds_read_b128 v[236:239], v19 offset:32768
    ds_read_b128 v[240:243], v0 offset:1024
    ds_read_b128 v[244:247], v0 offset:33792
    ds_read_b128 v[248:251], v19 offset:1024
    ds_read_b128 v[252:255], v19 offset:33792
    s_waitcnt lgkmcnt(7)
    v_mfma_f32_32x32x16_bf16 v[32:47], v[96:99], v[224:227], v[32:47]
    ds_read_b128 v[224:227], v0 offset:2048
    s_waitcnt lgkmcnt(7)
    v_mfma_f32_32x32x16_bf16 v[48:63], v[96:99], v[228:231], 0
    ds_read_b128 v[228:231], v0 offset:34816
    s_waitcnt lgkmcnt(7)
    v_mfma_f32_32x32x16_bf16 v[64:79], v[96:99], v[232:235], 0
    ds_read_b128 v[232:235], v19 offset:2048
    s_waitcnt lgkmcnt(7)
    s_cbranch_vccz L_m3_41
    v_mfma_f32_32x32x16_bf16 v[80:95], v[96:99], v[236:239], 0
L_m3_41:
    s_add_u32 m0, s100, 16384
    s_nop 0
    buffer_load_dwordx4 v23, s[52:55], s99 offen offset:0 sc1 lds
    buffer_load_dwordx4 v23, s[52:55], s99 offen offset:1024 sc1 lds
    buffer_load_dwordx4 v23, s[52:55], s99 offen offset:2048 sc1 lds
    buffer_load_dwordx4 v23, s[52:55], s99 offen offset:3072 sc1 lds
    s_add_u32 s99, s99, 4096
    s_cmp_eq_u32 s99, s91
    s_cselect_b32 s99, s90, s99
    ds_read_b128 v[236:239], v19 offset:34816
    s_waitcnt lgkmcnt(7)
    v_mfma_f32_32x32x16_bf16 v[32:47], v[100:103], v[240:243], v[32:47]
    ds_read_b128 v[240:243], v0 offset:3072
    s_waitcnt lgkmcnt(7)
    v_mfma_f32_32x32x16_bf16 v[48:63], v[100:103], v[244:247], v[48:63]
    ds_read_b128 v[244:247], v0 offset:35840
    s_waitcnt lgkmcnt(7)
    v_mfma_f32_32x32x16_bf16 v[64:79], v[100:103], v[248:251], v[64:79]
    ds_read_b128 v[248:251], v19 offset:3072
    s_waitcnt lgkmcnt(7)
    s_cbranch_vccz L_m3_42
    v_mfma_f32_32x32x16_bf16 v[80:95], v[100:103], v[252:255], v[80:95]
L_m3_42:
    s_add_u32 m0, s100, 20480
    s_nop 0
    buffer_load_dwordx4 v23, s[52:55], s99 offen offset:0 sc1 lds
    buffer_load_dwordx4 v23, s[52:55], s99 offen offset:1024 sc1 lds
    buffer_load_dwordx4 v23, s[52:55], s99 offen offset:2048 sc1 lds
    buffer_load_dwordx4 v23, s[52:55], s99 offen offset:3072 sc1 lds
    s_add_u32 s99, s99, 4096
    s_cmp_eq_u32 s99, s91
    s_cselect_b32 s99, s90, s99
    ds_read_b128 v[252:255], v19 offset:35840
    s_waitcnt lgkmcnt(7)
    v_mfma_f32_32x32x16_bf16 v[32:47], v[104:107], v[224:227], v[32:47]
    s_waitcnt lgkmcnt(6)
    v_mfma_f32_32x32x16_bf16 v[48:63], v[104:107], v[228:231], v[48:63]
    s_waitcnt lgkmcnt(5)
    v_mfma_f32_32x32x16_bf16 v[64:79], v[104:107], v[232:235], v[64:79]
    s_waitcnt lgkmcnt(4)
    s_cbranch_vccz L_m3_43
    v_mfma_f32_32x32x16_bf16 v[80:95], v[104:107], v[236:239], v[80:95]
L_m3_43:
    s_waitcnt lgkmcnt(3)
    v_mfma_f32_32x32x16_bf16 v[32:47], v[108:111], v[240:243], v[32:47]
    s_waitcnt lgkmcnt(2)
    v_mfma_f32_32x32x16_bf16 v[48:63], v[108:111], v[244:247], v[48:63]
    s_waitcnt lgkmcnt(1)
    v_mfma_f32_32x32x16_bf16 v[64:79], v[108:111], v[248:251], v[64:79]
    s_waitcnt lgkmcnt(0)
    s_cbranch_vccz L_m3_44
    v_mfma_f32_32x32x16_bf16 v[80:95], v[108:111], v[252:255], v[80:95]
L_m3_44:
    s_waitcnt vmcnt(8)
    s_waitcnt lgkmcnt(0)
    s_lshl_b32 s13, s92, 2
    v_mov_b32 v24, 4
    v_mov_b32 v25, s13
    s_mov_b64 exec, 1
    ds_write_b32 v25, v24 offset:8272
    s_mov_b64 exec, -1
    s_mov_b32 s14, 0
L_wp_45:
    ds_read_b128 v[24:27], v20 offset:8272
    s_add_u32 s14, s14, 1
    s_waitcnt lgkmcnt(0)
    v_min_u32 v24, v24, v25
    v_min3_u32 v24, v24, v26, v27
    s_cmp_gt_u32 s14, 1600000
    v_readfirstlane_b32 s13, v24
    s_cbranch_scc1 L_wpd_46
    s_cmp_ge_u32 s13, 4
    s_cbranch_scc0 L_wp_45
L_wpd_46:
    ds_read_b128 v[224:227], v0 offset:4096
    ds_read_b128 v[228:231], v0 offset:36864
    ds_read_b128 v[232:235], v19 offset:4096
    ds_read_b128 v[236:239], v19 offset:36864
    ds_read_b128 v[240:243], v0 offset:5120
    ds_read_b128 v[244:247], v0 offset:37888
    ds_read_b128 v[248:251], v19 offset:5120
    ds_read_b128 v[252:255], v19 offset:37888
    s_waitcnt lgkmcnt(7)
    v_mfma_f32_32x32x16_bf16 v[32:47], v[112:115], v[224:227], v[32:47]
    ds_read_b128 v[224:227], v0 offset:6144
    s_waitcnt lgkmcnt(7)
    v_mfma_f32_32x32x16_bf16 v[48:63], v[112:115], v[228:231], v[48:63]
    ds_read_b128 v[228:231], v0 offset:38912
    s_waitcnt lgkmcnt(7)
    v_mfma_f32_32x32x16_bf16 v[64:79], v[112:115], v[232:235], v[64:79]
    ds_read_b128 v[232:235], v19 offset:6144
    s_waitcnt lgkmcnt(7)
    s_cbranch_vccz L_m3_47
    v_mfma_f32_32x32x16_bf16 v[80:95], v[112:115], v[236:239], v[80:95]
L_m3_47:
    s_add_u32 m0, s100, 24576
    s_nop 0
    buffer_load_dwordx4 v23, s[52:55], s99 offen offset:0 sc1 lds
    buffer_load_dwordx4 v23, s[52:55], s99 offen offset:1024 sc1 lds
    buffer_load_dwordx4 v23, s[52:55], s99 offen offset:2048 sc1 lds
    buffer_load_dwordx4 v23, s[52:55], s99 offen offset:3072 sc1 lds
    s_add_u32 s99, s99, 4096
    s_cmp_eq_u32 s99, s91
    s_cselect_b32 s99, s90, s99
    ds_read_b128 v[236:239], v19 offset:38912
    s_waitcnt lgkmcnt(7)
    v_mfma_f32_32x32x16_bf16 v[32:47], v[116:119], v[240:243], v[32:47]
    ds_read_b128 v[240:243], v0 offset:7168
    s_waitcnt lgkmcnt(7)
    v_mfma_f32_32x32x16_bf16 v[48:63], v[116:119], v[244:247], v[48:63]
    ds_read_b128 v[244:247], v0 offset:39936
    s_waitcnt lgkmcnt(7)
    v_mfma_f32_32x32x16_bf16 v[64:79], v[116:119], v[248:251], v[64:79]
    ds_read_b128 v[248:251], v19 offset:7168
    s_waitcnt lgkmcnt(7)
    s_cbranch_vccz L_m3_48
    v_mfma_f32_32x32x16_bf16 v[80:95], v[116:119], v[252:255], v[80:95]
L_m3_48:
    s_add_u32 m0, s100, 28672
    s_nop 0
    buffer_load_dwordx4 v23, s[52:55], s99 offen offset:0 sc1 lds
    buffer_load_dwordx4 v23, s[52:55], s99 offen offset:1024 sc1 lds
    buffer_load_dwordx4 v23, s[52:55], s99 offen offset:2048 sc1 lds
    buffer_load_dwordx4 v23, s[52:55], s99 offen offset:3072 sc1 lds
    s_add_u32 s99, s99, 4096
    s_cmp_eq_u32 s99, s91
    s_cselect_b32 s99, s90, s99
    ds_read_b128 v[252:255], v19 offset:39936
    s_waitcnt lgkmcnt(7)
    v_mfma_f32_32x32x16_bf16 v[32:47], v[120:123], v[224:227], v[32:47]
    ds_read_b128 v[224:227], v0 offset:8192
    s_waitcnt lgkmcnt(7)
    v_mfma_f32_32x32x16_bf16 v[48:63], v[120:123], v[228:231], v[48:63]
    ds_read_b128 v[228:231], v0 offset:40960
    s_waitcnt lgkmcnt(7)
    v_mfma_f32_32x32x16_bf16 v[64:79], v[120:123], v[232:235], v[64:79]
    ds_read_b128 v[232:235], v19 offset:8192
    s_waitcnt lgkmcnt(7)
    s_cbranch_vccz L_m3_49
    v_mfma_f32_32x32x16_bf16 v[80:95], v[120:123], v[236:239], v[80:95]
L_m3_49:
    ds_read_b128 v[236:239], v19 offset:40960
    s_waitcnt lgkmcnt(7)
    v_mfma_f32_32x32x16_bf16 v[32:47], v[124:127], v[240:243], v[32:47]
    ds_read_b128 v[240:243], v0 offset:9216
    s_waitcnt lgkmcnt(7)
    v_mfma_f32_32x32x16_bf16 v[48:63], v[124:127], v[244:247], v[48:63]
    ds_read_b128 v[244:247], v0 offset:41984
    s_waitcnt lgkmcnt(7)
    v_mfma_f32_32x32x16_bf16 v[64:79], v[124:127], v[248:251], v[64:79]
    ds_read_b128 v[248:251], v19 offset:9216
    s_waitcnt lgkmcnt(7)
    s_cbranch_vccz L_m3_50
    v_mfma_f32_32x32x16_bf16 v[80:95], v[124:127], v[252:255], v[80:95]
L_m3_50:
    ds_read_b128 v[252:255], v19 offset:41984
    s_waitcnt lgkmcnt(7)
    v_mfma_f32_32x32x16_bf16 v[32:47], v[128:131], v[224:227], v[32:47]
    ds_read_b128 v[224:227], v0 offset:10240
    s_waitcnt lgkmcnt(7)
    v_mfma_f32_32x32x16_bf16 v[48:63], v[128:131], v[228:231], v[48:63]
    ds_read_b128 v[228:231], v0 offset:43008
    s_waitcnt lgkmcnt(7)
    v_mfma_f32_32x32x16_bf16 v[64:79], v[128:131], v[232:235], v[64:79]
    ds_read_b128 v[232:235], v19 offset:10240
    s_waitcnt lgkmcnt(7)
    s_cbranch_vccz L_m3_51
    v_mfma_f32_32x32x16_bf16 v[80:95], v[128:131], v[236:239], v[80:95]
L_m3_51:
    s_lshl_b32 s8, s5, 2
    s_add_u32 s8, s8, s92
    v_lshrrev_b32 v28, 2, v1
    v_lshlrev_b32 v28, 12, v28
    v_and_b32 v27, 3, v1
    v_lshl_add_u32 v28, v27, 7, v28
    s_lshl_b32 s8, s8, 16
    s_lshl_b32 s9, s20, 7
    s_add_u32 s8, s8, s9
    buffer_load_dword v30, v28, s[68:71], s8 offen
    s_mov_b64 exec, -1
    ds_read_b128 v[236:239], v19 offset:43008
    s_waitcnt lgkmcnt(7)
    v_mfma_f32_32x32x16_bf16 v[32:47], v[132:135], v[240:243], v[32:47]
    ds_read_b128 v[240:243], v0 offset:11264
    s_waitcnt lgkmcnt(7)
    v_mfma_f32_32x32x16_bf16 v[48:63], v[132:135], v[244:247], v[48:63]
    ds_read_b128 v[244:247], v0 offset:44032
    s_waitcnt lgkmcnt(7)
    v_mfma_f32_32x32x16_bf16 v[64:79], v[132:135], v[248:251], v[64:79]
    ds_read_b128 v[248:251], v19 offset:11264
    s_waitcnt lgkmcnt(7)
    s_cbranch_vccz L_m3_52
    v_mfma_f32_32x32x16_bf16 v[80:95], v[132:135], v[252:255], v[80:95]
L_m3_52:
    ds_read_b128 v[252:255], v19 offset:44032
    s_waitcnt lgkmcnt(7)
    v_mfma_f32_32x32x16_bf16 v[32:47], v[136:139], v[224:227], v[32:47]
    ds_read_b128 v[224:227], v0 offset:12288
    s_waitcnt lgkmcnt(7)
    v_mfma_f32_32x32x16_bf16 v[48:63], v[136:139], v[228:231], v[48:63]
    ds_read_b128 v[228:231], v0 offset:45056
    s_waitcnt lgkmcnt(7)
    v_mfma_f32_32x32x16_bf16 v[64:79], v[136:139], v[232:235], v[64:79]
    ds_read_b128 v[232:235], v19 offset:12288
    s_waitcnt lgkmcnt(7)
    s_cbranch_vccz L_m3_53
    v_mfma_f32_32x32x16_bf16 v[80:95], v[136:139], v[236:239], v[80:95]
L_m3_53:
    ds_read_b128 v[236:239], v19 offset:45056
    s_waitcnt lgkmcnt(7)
    v_mfma_f32_32x32x16_bf16 v[32:47], v[140:143], v[240:243], v[32:47]
    ds_read_b128 v[240:243], v0 offset:13312
    s_waitcnt lgkmcnt(7)
    v_mfma_f32_32x32x16_bf16 v[48:63], v[140:143], v[244:247], v[48:63]
    ds_read_b128 v[244:247], v0 offset:46080
    s_waitcnt lgkmcnt(7)
    v_mfma_f32_32x32x16_bf16 v[64:79], v[140:143], v[248:251], v[64:79]
    ds_read_b128 v[248:251], v19 offset:13312
    s_waitcnt lgkmcnt(7)
    s_cbranch_vccz L_m3_54
    v_mfma_f32_32x32x16_bf16 v[80:95], v[140:143], v[252:255], v[80:95]
L_m3_54:
    ds_read_b128 v[252:255], v19 offset:46080
    s_waitcnt lgkmcnt(7)
    v_mfma_f32_32x32x16_bf16 v[32:47], v[144:147], v[224:227], v[32:47]
    ds_read_b128 v[224:227], v0 offset:14336
    s_waitcnt lgkmcnt(7)
    v_mfma_f32_32x32x16_bf16 v[48:63], v[144:147], v[228:231], v[48:63]
    ds_read_b128 v[228:231], v0 offset:47104
    s_waitcnt lgkmcnt(7)
    v_mfma_f32_32x32x16_bf16 v[64:79], v[144:147], v[232:235], v[64:79]
    ds_read_b128 v[232:235], v19 offset:14336
    s_waitcnt lgkmcnt(7)
    s_cbranch_vccz L_m3_55
    v_mfma_f32_32x32x16_bf16 v[80:95], v[144:147], v[236:239], v[80:95]
L_m3_55:
    ds_read_b128 v[236:239], v19 offset:47104
    s_waitcnt lgkmcnt(7)
    v_mfma_f32_32x32x16_bf16 v[32:47], v[148:151], v[240:243], v[32:47]
    ds_read_b128 v[240:243], v0 offset:15360
    s_waitcnt lgkmcnt(7)
    v_mfma_f32_32x32x16_bf16 v[48:63], v[148:151], v[244:247], v[48:63]
    ds_read_b128 v[244:247], v0 offset:48128
    s_waitcnt lgkmcnt(7)
    v_mfma_f32_32x32x16_bf16 v[64:79], v[148:151], v[248:251], v[64:79]
    ds_read_b128 v[248:251], v19 offset:15360
    s_waitcnt lgkmcnt(7)
    s_cbranch_vccz L_m3_56
    v_mfma_f32_32x32x16_bf16 v[80:95], v[148:151], v[252:255], v[80:95]
L_m3_56:
    ds_read_b128 v[252:255], v19 offset:48128
    s_waitcnt lgkmcnt(7)
    v_mfma_f32_32x32x16_bf16 v[32:47], v[152:155], v[224:227], v[32:47]
    s_waitcnt lgkmcnt(6)
    v_mfma_f32_32x32x16_bf16 v[48:63], v[152:155], v[228:231], v[48:63]
    s_waitcnt lgkmcnt(5)
    v_mfma_f32_32x32x16_bf16 v[64:79], v[152:155], v[232:235], v[64:79]
    s_waitcnt lgkmcnt(4)
    s_cbranch_vccz L_m3_57
    v_mfma_f32_32x32x16_bf16 v[80:95], v[152:155], v[236:239], v[80:95]
L_m3_57:
    s_waitcnt lgkmcnt(3)
    v_mfma_f32_32x32x16_bf16 v[32:47], v[156:159], v[240:243], v[32:47]
    s_waitcnt lgkmcnt(2)
    v_mfma_f32_32x32x16_bf16 v[48:63], v[156:159], v[244:247], v[48:63]
    s_waitcnt lgkmcnt(1)
    v_mfma_f32_32x32x16_bf16 v[64:79], v[156:159], v[248:251], v[64:79]
    s_waitcnt lgkmcnt(0)
    s_cbranch_vccz L_m3_58
    v_mfma_f32_32x32x16_bf16 v[80:95], v[156:159], v[252:255], v[80:95]
L_m3_58:
    s_waitcnt vmcnt(1)
    s_waitcnt lgkmcnt(0)
    s_lshl_b32 s13, s92, 2
    v_mov_b32 v24, 5
    v_mov_b32 v25, s13
    s_mov_b64 exec, 1
    ds_write_b32 v25, v24 offset:8272
    s_mov_b64 exec, -1
    s_mov_b32 s14, 0
L_wp_59:
    ds_read_b128 v[24:27], v20 offset:8272
    s_add_u32 s14, s14, 1
    s_waitcnt lgkmcnt(0)
    v_min_u32 v24, v24, v25
    v_min3_u32 v24, v24, v26, v27
    s_cmp_gt_u32 s14, 1600000
    v_readfirstlane_b32 s13, v24
    s_cbranch_scc1 L_wpd_60
    s_cmp_ge_u32 s13, 5
    s_cbranch_scc0 L_wp_59
L_wpd_60:
    ds_read_b128 v[224:227], v0 offset:16384
    ds_read_b128 v[228:231], v0 offset:49152
    ds_read_b128 v[232:235], v19 offset:16384
    ds_read_b128 v[236:239], v19 offset:49152
    ds_read_b128 v[240:243], v0 offset:17408
    ds_read_b128 v[244:247], v0 offset:50176
    ds_read_b128 v[248:251], v19 offset:17408
    ds_read_b128 v[252:255], v19 offset:50176
    s_waitcnt lgkmcnt(7)
    v_mfma_f32_32x32x16_bf16 v[32:47], v[160:163], v[224:227], v[32:47]
    ds_read_b128 v[224:227], v0 offset:18432
    s_waitcnt lgkmcnt(7)
    v_mfma_f32_32x32x16_bf16 v[48:63], v[160:163], v[228:231], v[48:63]
    ds_read_b128 v[228:231], v0 offset:51200
    s_waitcnt lgkmcnt(7)
    v_mfma_f32_32x32x16_bf16 v[64:79], v[160:163], v[232:235], v[64:79]
    ds_read_b128 v[232:235], v19 offset:18432
    s_waitcnt lgkmcnt(7)
    s_cbranch_vccz L_m3_61
    v_mfma_f32_32x32x16_bf16 v[80:95], v[160:163], v[236:239], v[80:95]
L_m3_61:
    ds_read_b128 v[236:239], v19 offset:51200
    s_waitcnt lgkmcnt(7)
    v_mfma_f32_32x32x16_bf16 v[32:47], v[164:167], v[240:243], v[32:47]
    ds_read_b128 v[240:243], v0 offset:19456
    s_waitcnt lgkmcnt(7)
    v_mfma_f32_32x32x16_bf16 v[48:63], v[164:167], v[244:247], v[48:63]
    ds_read_b128 v[244:247], v0 offset:52224
    s_waitcnt lgkmcnt(7)
    v_mfma_f32_32x32x16_bf16 v[64:79], v[164:167], v[248:251], v[64:79]
    ds_read_b128 v[248:251], v19 offset:19456
    s_waitcnt lgkmcnt(7)
    s_cbranch_vccz L_m3_62
    v_mfma_f32_32x32x16_bf16 v[80:95], v[164:167], v[252:255], v[80:95]
L_m3_62:
    ds_read_b128 v[252:255], v19 offset:52224
    s_waitcnt lgkmcnt(7)
    v_mfma_f32_32x32x16_bf16 v[32:47], v[168:171], v[224:227], v[32:47]
    ds_read_b128 v[224:227], v0 offset:20480
    s_waitcnt lgkmcnt(7)
    v_mfma_f32_32x32x16_bf16 v[48:63], v[168:171], v[228:231], v[48:63]
    ds_read_b128 v[228:231], v0 offset:53248
    s_waitcnt lgkmcnt(7)
    v_mfma_f32_32x32x16_bf16 v[64:79], v[168:171], v[232:235], v[64:79]
    ds_read_b128 v[232:235], v19 offset:20480
    s_waitcnt lgkmcnt(7)
    s_cbranch_vccz L_m3_63
    v_mfma_f32_32x32x16_bf16 v[80:95], v[168:171], v[236:239], v[80:95]
L_m3_63:
    ds_read_b128 v[236:239], v19 offset:53248
    s_waitcnt lgkmcnt(7)
    v_mfma_f32_32x32x16_bf16 v[32:47], v[172:175], v[240:243], v[32:47]
    ds_read_b128 v[240:243], v0 offset:21504
    s_waitcnt lgkmcnt(7)
    v_mfma_f32_32x32x16_bf16 v[48:63], v[172:175], v[244:247], v[48:63]
    ds_read_b128 v[244:247], v0 offset:54272
    s_waitcnt lgkmcnt(7)
    v_mfma_f32_32x32x16_bf16 v[64:79], v[172:175], v[248:251], v[64:79]
    ds_read_b128 v[248:251], v19 offset:21504
    s_waitcnt lgkmcnt(7)
    s_cbranch_vccz L_m3_64
    v_mfma_f32_32x32x16_bf16 v[80:95], v[172:175], v[252:255], v[80:95]
L_m3_64:
    ds_read_b128 v[252:255], v19 offset:54272
    s_waitcnt lgkmcnt(7)
    v_mfma_f32_32x32x16_bf16 v[32:47], v[176:179], v[224:227], v[32:47]
    ds_read_b128 v[224:227], v0 offset:22528
    s_waitcnt lgkmcnt(7)
    v_mfma_f32_32x32x16_bf16 v[48:63], v[176:179], v[228:231], v[48:63]
    ds_read_b128 v[228:231], v0 offset:55296
    s_waitcnt lgkmcnt(7)
    v_mfma_f32_32x32x16_bf16 v[64:79], v[176:179], v[232:235], v[64:79]
    ds_read_b128 v[232:235], v19 offset:22528
    s_waitcnt lgkmcnt(7)
    s_cbranch_vccz L_m3_65
    v_mfma_f32_32x32x16_bf16 v[80:95], v[176:179], v[236:239], v[80:95]
L_m3_65:
    s_lshl_b32 s8, s5, 2
    s_add_u32 s8, s8, s92
    s_mul_i32 s8, s8, 3584
    v_min_u32 v28, 27, v1
    v_lshlrev_b32 v28, 7, v28
    buffer_load_dword v30, v28, s[56:59], s8 offen
    ds_read_b128 v[236:239], v19 offset:55296
    s_waitcnt lgkmcnt(7)
    v_mfma_f32_32x32x16_bf16 v[32:47], v[180:183], v[240:243], v[32:47]
    ds_read_b128 v[240:243], v0 offset:23552
    s_waitcnt lgkmcnt(7)
    v_mfma_f32_32x32x16_bf16 v[48:63], v[180:183], v[244:247], v[48:63]
    ds_read_b128 v[244:247], v0 offset:56320
    s_waitcnt lgkmcnt(7)
    v_mfma_f32_32x32x16_bf16 v[64:79], v[180:183], v[248:251], v[64:79]
    ds_read_b128 v[248:251], v19 offset:23552
    s_waitcnt lgkmcnt(7)
    s_cbranch_vccz L_m3_66
    v_mfma_f32_32x32x16_bf16 v[80:95], v[180:183], v[252:255], v[80:95]
L_m3_66:
    ds_read_b128 v[252:255], v19 offset:56320
    s_waitcnt lgkmcnt(7)
    v_mfma_f32_32x32x16_bf16 v[32:47], v[184:187], v[224:227], v[32:47]
    ds_read_b128 v[224:227], v0 offset:24576
    s_waitcnt lgkmcnt(7)
    v_mfma_f32_32x32x16_bf16 v[48:63], v[184:187], v[228:231], v[48:63]
    ds_read_b128 v[228:231], v0 offset:57344
    s_waitcnt lgkmcnt(7)
    v_mfma_f32_32x32x16_bf16 v[64:79], v[184:187], v[232:235], v[64:79]
    ds_read_b128 v[232:235], v19 offset:24576
    s_waitcnt lgkmcnt(7)
    s_cbranch_vccz L_m3_67
    v_mfma_f32_32x32x16_bf16 v[80:95], v[184:187], v[236:239], v[80:95]
L_m3_67:
    ds_read_b128 v[236:239], v19 offset:57344
    s_waitcnt lgkmcnt(7)
    v_mfma_f32_32x32x16_bf16 v[32:47], v[188:191], v[240:243], v[32:47]
    ds_read_b128 v[240:243], v0 offset:25600
    s_waitcnt lgkmcnt(7)
    v_mfma_f32_32x32x16_bf16 v[48:63], v[188:191], v[244:247], v[48:63]
    ds_read_b128 v[244:247], v0 offset:58368
    s_waitcnt lgkmcnt(7)
    v_mfma_f32_32x32x16_bf16 v[64:79], v[188:191], v[248:251], v[64:79]
    ds_read_b128 v[248:251], v19 offset:25600
    s_waitcnt lgkmcnt(7)
    s_cbranch_vccz L_m3_68
    v_mfma_f32_32x32x16_bf16 v[80:95], v[188:191], v[252:255], v[80:95]
L_m3_68:
    ds_read_b128 v[252:255], v19 offset:58368
    s_waitcnt lgkmcnt(7)
    v_mfma_f32_32x32x16_bf16 v[32:47], v[192:195], v[224:227], v[32:47]
    ds_read_b128 v[224:227], v0 offset:26624
    s_waitcnt lgkmcnt(7)
    v_mfma_f32_32x32x16_bf16 v[48:63], v[192:195], v[228:231], v[48:63]
    ds_read_b128 v[228:231], v0 offset:59392
    s_waitcnt lgkmcnt(7)
    v_mfma_f32_32x32x16_bf16 v[64:79], v[192:195], v[232:235], v[64:79]
    ds_read_b128 v[232:235], v19 offset:26624
    s_waitcnt lgkmcnt(7)
    s_cbranch_vccz L_m3_69
    v_mfma_f32_32x32x16_bf16 v[80:95], v[192:195], v[236:239], v[80:95]
L_m3_69:
    ds_read_b128 v[236:239], v19 offset:59392
    s_waitcnt lgkmcnt(7)
    v_mfma_f32_32x32x16_bf16 v[32:47], v[196:199], v[240:243], v[32:47]
    ds_read_b128 v[240:243], v0 offset:27648
    s_waitcnt lgkmcnt(7)
    v_mfma_f32_32x32x16_bf16 v[48:63], v[196:199], v[244:247], v[48:63]
    ds_read_b128 v[244:247], v0 offset:60416
    s_waitcnt lgkmcnt(7)
    v_mfma_f32_32x32x16_bf16 v[64:79], v[196:199], v[248:251], v[64:79]
    ds_read_b128 v[248:251], v19 offset:27648
    s_waitcnt lgkmcnt(7)
    s_cbranch_vccz L_m3_70
    v_mfma_f32_32x32x16_bf16 v[80:95], v[196:199], v[252:255], v[80:95]
L_m3_70:
    ds_read_b128 v[252:255], v19 offset:60416
    s_waitcnt lgkmcnt(7)
    v_mfma_f32_32x32x16_bf16 v[32:47], v[200:203], v[224:227], v[32:47]
    ds_read_b128 v[224:227], v0 offset:28672
    s_waitcnt lgkmcnt(7)
    v_mfma_f32_32x32x16_bf16 v[48:63], v[200:203], v[228:231], v[48:63]
    ds_read_b128 v[228:231], v0 offset:61440
    s_waitcnt lgkmcnt(7)
    v_mfma_f32_32x32x16_bf16 v[64:79], v[200:203], v[232:235], v[64:79]
    ds_read_b128 v[232:235], v19 offset:28672
    s_waitcnt lgkmcnt(7)
    s_cbranch_vccz L_m3_71
    v_mfma_f32_32x32x16_bf16 v[80:95], v[200:203], v[236:239], v[80:95]
L_m3_71:
    ds_read_b128 v[236:239], v19 offset:61440
    s_waitcnt lgkmcnt(7)
    v_mfma_f32_32x32x16_bf16 v[32:47], v[204:207], v[240:243], v[32:47]
    ds_read_b128 v[240:243], v0 offset:29696
    s_waitcnt lgkmcnt(7)
    v_mfma_f32_32x32x16_bf16 v[48:63], v[204:207], v[244:247], v[48:63]
    ds_read_b128 v[244:247], v0 offset:62464
    s_waitcnt lgkmcnt(7)
    v_mfma_f32_32x32x16_bf16 v[64:79], v[204:207], v[248:251], v[64:79]
    ds_read_b128 v[248:251], v19 offset:29696
    s_waitcnt lgkmcnt(7)
    s_cbranch_vccz L_m3_72
    v_mfma_f32_32x32x16_bf16 v[80:95], v[204:207], v[252:255], v[80:95]
L_m3_72:
    ds_read_b128 v[252:255], v19 offset:62464
    s_waitcnt lgkmcnt(7)
    v_mfma_f32_32x32x16_bf16 v[32:47], v[208:211], v[224:227], v[32:47]
    ds_read_b128 v[224:227], v0 offset:30720
    s_waitcnt lgkmcnt(7)
    v_mfma_f32_32x32x16_bf16 v[48:63], v[208:211], v[228:231], v[48:63]
    ds_read_b128 v[228:231], v0 offset:63488
    s_waitcnt lgkmcnt(7)
    v_mfma_f32_32x32x16_bf16 v[64:79], v[208:211], v[232:235], v[64:79]
    ds_read_b128 v[232:235], v19 offset:30720
    s_waitcnt lgkmcnt(7)
    s_cbranch_vccz L_m3_73
    v_mfma_f32_32x32x16_bf16 v[80:95], v[208:211], v[236:239], v[80:95]
L_m3_73:
    ds_read_b128 v[236:239], v19 offset:63488
    s_waitcnt lgkmcnt(7)
    v_mfma_f32_32x32x16_bf16 v[32:47], v[212:215], v[240:243], v[32:47]
    ds_read_b128 v[240:243], v0 offset:31744
    s_waitcnt lgkmcnt(7)
    v_mfma_f32_32x32x16_bf16 v[48:63], v[212:215], v[244:247], v[48:63]
    ds_read_b128 v[244:247], v0 offset:64512
    s_waitcnt lgkmcnt(7)
    v_mfma_f32_32x32x16_bf16 v[64:79], v[212:215], v[248:251], v[64:79]
    ds_read_b128 v[248:251], v19 offset:31744
    s_waitcnt lgkmcnt(7)
    s_cbranch_vccz L_m3_74
    v_mfma_f32_32x32x16_bf16 v[80:95], v[212:215], v[252:255], v[80:95]
L_m3_74:
    ds_read_b128 v[252:255], v19 offset:64512
    s_waitcnt lgkmcnt(7)
    v_mfma_f32_32x32x16_bf16 v[32:47], v[216:219], v[224:227], v[32:47]
    s_waitcnt lgkmcnt(6)
    v_mfma_f32_32x32x16_bf16 v[48:63], v[216:219], v[228:231], v[48:63]
    s_waitcnt lgkmcnt(5)
    v_mfma_f32_32x32x16_bf16 v[64:79], v[216:219], v[232:235], v[64:79]
    s_waitcnt lgkmcnt(4)
    s_cbranch_vccz L_m3_75
    v_mfma_f32_32x32x16_bf16 v[80:95], v[216:219], v[236:239], v[80:95]
L_m3_75:
    s_waitcnt lgkmcnt(3)
    v_mfma_f32_32x32x16_bf16 v[32:47], v[220:223], v[240:243], v[32:47]
    s_waitcnt lgkmcnt(2)
    v_mfma_f32_32x32x16_bf16 v[48:63], v[220:223], v[244:247], v[48:63]
    s_waitcnt lgkmcnt(1)
    v_mfma_f32_32x32x16_bf16 v[64:79], v[220:223], v[248:251], v[64:79]
    s_waitcnt lgkmcnt(0)
    s_cbranch_vccz L_m3_76
    v_mfma_f32_32x32x16_bf16 v[80:95], v[220:223], v[252:255], v[80:95]
L_m3_76:
    s_setprio 2
    s_lshl_b32 s13, s92, 2
    v_mov_b32 v24, 6
    v_mov_b32 v25, s13
    s_mov_b64 exec, 1
    ds_write_b32 v25, v24 offset:8272
    s_mov_b64 exec, -1
    s_mov_b64 exec, 1
    ds_add_u32 v20, v21 offset:8228
    s_mov_b64 exec, -1
    s_lshl_b32 s12, s23, 2
    s_add_u32 s12, s12, s92
    s_lshl_b32 s12, s12, 2
    s_add_u32 s12, s12, s21
    s_lshl_b32 s12, s12, 11
    s_add_u32 s12, s12, 8388608
    v_cvt_pk_bf16_f32 v184, v48, v49
    v_cvt_pk_bf16_f32 v185, v50, v51
    v_cvt_pk_bf16_f32 v186, v52, v53
    v_cvt_pk_bf16_f32 v187, v54, v55
    v_cvt_pk_bf16_f32 v188, v56, v57
    v_cvt_pk_bf16_f32 v189, v58, v59
    v_cvt_pk_bf16_f32 v190, v60, v61
    v_cvt_pk_bf16_f32 v191, v62, v63
    s_bfe_u32 s9, s22, 131074
    s_lshl_b32 s9, s9, 15
    s_add_u32 s9, s9, s12
    buffer_store_dwordx4 v[184:187], v23, s[84:87], s9 offen sc1
    buffer_store_dwordx4 v[188:191], v23, s[84:87], s9 offen offset:1024 sc1
L_ps_77:
    v_cvt_pk_bf16_f32 v192, v64, v65
    v_cvt_pk_bf16_f32 v193, v66, v67
    v_cvt_pk_bf16_f32 v194, v68, v69
    v_cvt_pk_bf16_f32 v195, v70, v71
    v_cvt_pk_bf16_f32 v196, v72, v73
    v_cvt_pk_bf16_f32 v197, v74, v75
    v_cvt_pk_bf16_f32 v198, v76, v77
    v_cvt_pk_bf16_f32 v199, v78, v79
    s_bfe_u32 s9, s22, 131076
    s_lshl_b32 s9, s9, 15
    s_add_u32 s9, s9, s12
    buffer_store_dwordx4 v[192:195], v23, s[84:87], s9 offen sc1
    buffer_store_dwordx4 v[196:199], v23, s[84:87], s9 offen offset:1024 sc1
L_ps_78:
    s_cmp_lg_u32 s41, 0
    s_cbranch_scc1 L_ps_79
    v_cvt_pk_bf16_f32 v176, v32, v33
    v_cvt_pk_bf16_f32 v177, v34, v35
    v_cvt_pk_bf16_f32 v178, v36, v37
    v_cvt_pk_bf16_f32 v179, v38, v39
    v_cvt_pk_bf16_f32 v180, v40, v41
    v_cvt_pk_bf16_f32 v181, v42, v43
    v_cvt_pk_bf16_f32 v182, v44, v45
    v_cvt_pk_bf16_f32 v183, v46, v47
    s_bfe_u32 s9, s22, 131072
    s_lshl_b32 s9, s9, 15
    s_add_u32 s9, s9, s12
    buffer_store_dwordx4 v[176:179], v23, s[84:87], s9 offen sc1
    buffer_store_dwordx4 v[180:183], v23, s[84:87], s9 offen offset:1024 sc1
L_ps_79:
    s_cbranch_vccz L_ps_80
    v_cvt_pk_bf16_f32 v200, v80, v81
    v_cvt_pk_bf16_f32 v201, v82, v83
    v_cvt_pk_bf16_f32 v202, v84, v85
    v_cvt_pk_bf16_f32 v203, v86, v87
    v_cvt_pk_bf16_f32 v204, v88, v89
    v_cvt_pk_bf16_f32 v205, v90, v91
    v_cvt_pk_bf16_f32 v206, v92, v93
    v_cvt_pk_bf16_f32 v207, v94, v95
    s_bfe_u32 s9, s22, 131078
    s_lshl_b32 s9, s9, 15
    s_add_u32 s9, s9, s12
    buffer_store_dwordx4 v[200:203], v23, s[84:87], s9 offen sc1
    buffer_store_dwordx4 v[204:207], v23, s[84:87], s9 offen offset:1024 sc1
L_ps_80:
    s_mov_b32 s14, 0
L_wp_81:
    ds_read_b128 v[24:27], v20 offset:8272
    s_add_u32 s14, s14, 1
    s_waitcnt lgkmcnt(0)
    v_min_u32 v24, v24, v25
    v_min3_u32 v24, v24, v26, v27
    s_cmp_gt_u32 s14, 1600000
    v_readfirstlane_b32 s13, v24
    s_cbranch_scc1 L_wpd_82
    s_cmp_ge_u32 s13, 6
    s_cbranch_scc0 L_wp_81
L_wpd_82:
    v_mul_u32_u24 v10, 4096, v14
    v_add_u32 v10, v10, v15
    v_add_u32 v11, 31744, v10
    v_add_u32 v12, 31744, v11
    v_add_u32 v13, 31744, v12
    s_mul_i32 s88, s92, 1835008
    s_lshl_b32 s8, s95, 7
    s_add_u32 s88, s88, s8
    s_add_u32 s89, s88, 1835008
    s_mul_i32 s8, s17, 131072
    s_add_u32 s98, s88, s8
    s_add_u32 m0, s101, 0
    s_nop 0
    buffer_load_dwordx4 v10, s[68:71], s98 offen offset:0 lds
    buffer_load_dwordx4 v11, s[68:71], s98 offen offset:1024 lds
    buffer_load_dwordx4 v12, s[68:71], s98 offen offset:2048 lds
    buffer_load_dwordx4 v13, s[68:71], s98 offen offset:3072 lds
    s_add_u32 s98, s98, 131072
    s_cmp_eq_u32 s98, s89
    s_cselect_b32 s98, s88, s98
    s_and_b32 s12, s2, 0xf9
    s_lshl_b32 s12, s12, 10
    s_lshl_b32 s8, s92, 7
    s_add_u32 s12, s12, s8
    s_add_u32 s12, s12, 6291712
    s_xor_b32 s9, s21, 1
    s_lshl_b32 s9, s9, 11
    s_add_u32 s9, s9, s12
    s_xor_b32 s10, s21, 2
    s_lshl_b32 s10, s10, 11
    s_add_u32 s10, s10, s12
    s_xor_b32 s11, s21, 3
    s_lshl_b32 s11, s11, 11
    s_add_u32 s11, s11, s12
    s_lshl_b32 s8, s21, 11
    s_add_u32 s12, s12, s8
    s_waitcnt vmcnt(4)
    s_atomic_add s26, s[84:85], s9 offset:0
    s_atomic_add s26, s[84:85], s10 offset:0
    s_atomic_add s26, s[84:85], s11 offset:0
    s_add_u32 m0, s101, 4096
    s_nop 0
    buffer_load_dwordx4 v10, s[68:71], s98 offen offset:0 lds
    buffer_load_dwordx4 v11, s[68:71], s98 offen offset:1024 lds
    buffer_load_dwordx4 v12, s[68:71], s98 offen offset:2048 lds
    buffer_load_dwordx4 v13, s[68:71], s98 offen offset:3072 lds
    s_add_u32 s98, s98, 131072
    s_cmp_eq_u32 s98, s89
    s_cselect_b32 s98, s88, s98
    s_add_u32 m0, s101, 8192
    s_nop 0
    buffer_load_dwordx4 v10, s[68:71], s98 offen offset:0 lds
    buffer_load_dwordx4 v11, s[68:71], s98 offen offset:1024 lds
    buffer_load_dwordx4 v12, s[68:71], s98 offen offset:2048 lds
    buffer_load_dwordx4 v13, s[68:71], s98 offen offset:3072 lds
    s_add_u32 s98, s98, 131072
    s_cmp_eq_u32 s98, s89
    s_cselect_b32 s98, s88, s98
    s_add_u32 m0, s101, 12288
    s_nop 0
    buffer_load_dwordx4 v10, s[68:71], s98 offen offset:0 lds
    buffer_load_dwordx4 v11, s[68:71], s98 offen offset:1024 lds
    buffer_load_dwordx4 v12, s[68:71], s98 offen offset:2048 lds
    buffer_load_dwordx4 v13, s[68:71], s98 offen offset:3072 lds
    s_add_u32 s98, s98, 131072
    s_cmp_eq_u32 s98, s89
    s_cselect_b32 s98, s88, s98
    s_add_u32 m0, s101, 16384
    s_nop 0
    buffer_load_dwordx4 v10, s[68:71], s98 offen offset:0 lds
    buffer_load_dwordx4 v11, s[68:71], s98 offen offset:1024 lds
    buffer_load_dwordx4 v12, s[68:71], s98 offen offset:2048 lds
    buffer_load_dwordx4 v13, s[68:71], s98 offen offset:3072 lds
    s_add_u32 s98, s98, 131072
    s_cmp_eq_u32 s98, s89
    s_cselect_b32 s98, s88, s98
    s_add_u32 m0, s101, 20480
    s_nop 0
    buffer_load_dwordx4 v10, s[68:71], s98 offen offset:0 lds
    buffer_load_dwordx4 v11, s[68:71], s98 offen offset:1024 lds
    buffer_load_dwordx4 v12, s[68:71], s98 offen offset:2048 lds
    buffer_load_dwordx4 v13, s[68:71], s98 offen offset:3072 lds
    s_add_u32 s98, s98, 131072
    s_cmp_eq_u32 s98, s89
    s_cselect_b32 s98, s88, s98
    s_mov_b32 s14, 0
L_sp_83:
    s_load_dword s13, s[84:85], s12 offset:0 glc
    s_add_u32 s14, s14, 1
    s_waitcnt lgkmcnt(0)
    s_cmp_ge_u32 s13, 3
    s_cbranch_scc1 L_spd_84
    s_cmp_gt_u32 s14, 400000
    s_cbranch_scc0 L_sp_83
L_spd_84:
    s_add_u32 s12, s23, s21
    s_lshl_b32 s12, s12, 2
    s_add_u32 s12, s12, s92
    s_lshl_b32 s12, s12, 13
    s_add_u32 s12, s12, 8388608
    s_cmp_eq_u32 s41, 0
    s_cselect_b32 s12, 16777216, s12
    s_xor_b32 s9, s21, 1
    s_lshl_b32 s9, s9, 11
    s_add_u32 s9, s9, s12
    buffer_load_dwordx4 v[176:179], v23, s[84:87], s9 offen sc1
    buffer_load_dwordx4 v[180:183], v23, s[84:87], s9 offen offset:1024 sc1
    s_xor_b32 s9, s21, 2
    s_lshl_b32 s9, s9, 11
    s_add_u32 s9, s9, s12
    buffer_load_dwordx4 v[184:187], v23, s[84:87], s9 offen sc1
    buffer_load_dwordx4 v[188:191], v23, s[84:87], s9 offen offset:1024 sc1
    s_xor_b32 s9, s21, 3
    s_lshl_b32 s9, s9, 11
    s_add_u32 s9, s9, s12
    buffer_load_dwordx4 v[192:195], v23, s[84:87], s9 offen sc1
    buffer_load_dwordx4 v[196:199], v23, s[84:87], s9 offen offset:1024 sc1
    s_mov_b32 s10, 0x00003f80
    s_mov_b32 s11, 0x3f800000
    s_add_u32 s8, s40, s21
    s_lshr_b32 s12, s8, 1
    s_mul_i32 s12, s12, 112
    s_lshl_b32 s9, s93, 3
    s_add_u32 s12, s12, s9
    s_lshl_b32 s9, s92, 1
    s_add_u32 s12, s12, s9
    s_lshl_b32 s12, s12, 1
    s_and_b32 s9, s8, 1
    s_add_u32 s12, s12, s9
    s_lshl_b32 s12, s12, 10
    s_add_u32 s12, s12, 2097152
    s_lshl_b32 s9, s93, 2
    s_add_u32 s9, s9, s92
    s_mul_i32 s9, s9, 4682
    s_lshr_b32 s9, s9, 16
    s_lshr_b32 s8, s8, 1
    s_lshl_b32 s8, s8, 2
    s_add_u32 s9, s9, s8
    s_lshl_b32 s9, s9, 13
    s_add_u32 s9, s9, 6292224
    s_cmp_eq_u32 s41, 0
    s_cselect_b32 s12, 16777216, s12
    v_mov_b32 v24, 0xbdd2d3e8
    v_mov_b32 v26, 0xc0135761
    s_waitcnt vmcnt(4)
    ds_read_b64_tr_b16 v[96:97], v4 offset:0
    ds_read_b64_tr_b16 v[98:99], v4 offset:1024
    ds_read_b64_tr_b16 v[100:101], v5 offset:0
    ds_read_b64_tr_b16 v[102:103], v5 offset:1024
    ds_read_b64_tr_b16 v[104:105], v4 offset:2048
    ds_read_b64_tr_b16 v[106:107], v4 offset:3072
    ds_read_b64_tr_b16 v[108:109], v5 offset:2048
    ds_read_b64_tr_b16 v[110:111], v5 offset:3072
    ds_read_b64_tr_b16 v[112:113], v4 offset:4096
    ds_read_b64_tr_b16 v[114:115], v4 offset:5120
    ds_read_b64_tr_b16 v[116:117], v5 offset:4096
    ds_read_b64_tr_b16 v[118:119], v5 offset:5120
    ds_read_b64_tr_b16 v[120:121], v4 offset:6144
    ds_read_b64_tr_b16 v[122:123], v4 offset:7168
    ds_read_b64_tr_b16 v[124:125], v5 offset:6144
    ds_read_b64_tr_b16 v[126:127], v5 offset:7168
    ds_read_b64_tr_b16 v[128:129], v4 offset:8192
    ds_read_b64_tr_b16 v[130:131], v4 offset:9216
    ds_read_b64_tr_b16 v[132:133], v5 offset:8192
    ds_read_b64_tr_b16 v[134:135], v5 offset:9216
    ds_read_b64_tr_b16 v[136:137], v4 offset:10240
    ds_read_b64_tr_b16 v[138:139], v4 offset:11264
    ds_read_b64_tr_b16 v[140:141], v5 offset:10240
    ds_read_b64_tr_b16 v[142:143], v5 offset:11264
    ds_read_b64_tr_b16 v[144:145], v4 offset:12288
    ds_read_b64_tr_b16 v[146:147], v4 offset:13312
    ds_read_b64_tr_b16 v[148:149], v5 offset:12288
    ds_read_b64_tr_b16 v[150:151], v5 offset:13312
    ds_read_b64_tr_b16 v[152:153], v4 offset:14336
    ds_read_b64_tr_b16 v[154:155], v4 offset:15360
    ds_read_b64_tr_b16 v[156:157], v5 offset:14336
    ds_read_b64_tr_b16 v[158:159], v5 offset:15360
    ds_read_b64_tr_b16 v[160:161], v4 offset:16384
    ds_read_b64_tr_b16 v[162:163], v4 offset:17408
    ds_read_b64_tr_b16 v[164:165], v5 offset:16384
    ds_read_b64_tr_b16 v[166:167], v5 offset:17408
    ds_read_b64_tr_b16 v[168:169], v4 offset:18432
    ds_read_b64_tr_b16 v[170:171], v4 offset:19456
    ds_read_b64_tr_b16 v[172:173], v5 offset:18432
    ds_read_b64_tr_b16 v[174:175], v5 offset:19456
    v_dot2_f32_bf16 v32, v176, s10, v32
    v_dot2_f32_bf16 v33, v176, s11, v33
    v_dot2_f32_bf16 v34, v177, s10, v34
    v_dot2_f32_bf16 v35, v177, s11, v35
    v_dot2_f32_bf16 v36, v178, s10, v36
    v_dot2_f32_bf16 v37, v178, s11, v37
    v_dot2_f32_bf16 v38, v179, s10, v38
    v_dot2_f32_bf16 v39, v179, s11, v39
    v_dot2_f32_bf16 v40, v180, s10, v40
    v_dot2_f32_bf16 v41, v180, s11, v41
    v_dot2_f32_bf16 v42, v181, s10, v42
    v_dot2_f32_bf16 v43, v181, s11, v43
    v_dot2_f32_bf16 v44, v182, s10, v44
    v_dot2_f32_bf16 v45, v182, s11, v45
    v_dot2_f32_bf16 v46, v183, s10, v46
    v_dot2_f32_bf16 v47, v183, s11, v47
    s_waitcnt vmcnt(2)
    v_dot2_f32_bf16 v32, v184, s10, v32
    v_dot2_f32_bf16 v33, v184, s11, v33
    v_dot2_f32_bf16 v34, v185, s10, v34
    v_dot2_f32_bf16 v35, v185, s11, v35
    v_dot2_f32_bf16 v36, v186, s10, v36
    v_dot2_f32_bf16 v37, v186, s11, v37
    v_dot2_f32_bf16 v38, v187, s10, v38
    v_dot2_f32_bf16 v39, v187, s11, v39
    v_dot2_f32_bf16 v40, v188, s10, v40
    v_dot2_f32_bf16 v41, v188, s11, v41
    v_dot2_f32_bf16 v42, v189, s10, v42
    v_dot2_f32_bf16 v43, v189, s11, v43
    v_dot2_f32_bf16 v44, v190, s10, v44
    v_dot2_f32_bf16 v45, v190, s11, v45
    v_dot2_f32_bf16 v46, v191, s10, v46
    v_dot2_f32_bf16 v47, v191, s11, v47
    s_waitcnt vmcnt(0)
    v_dot2_f32_bf16 v32, v192, s10, v32
    v_dot2_f32_bf16 v33, v192, s11, v33
    v_dot2_f32_bf16 v34, v193, s10, v34
    v_dot2_f32_bf16 v35, v193, s11, v35
    v_dot2_f32_bf16 v36, v194, s10, v36
    v_dot2_f32_bf16 v37, v194, s11, v37
    v_dot2_f32_bf16 v38, v195, s10, v38
    v_dot2_f32_bf16 v39, v195, s11, v39
    v_dot2_f32_bf16 v40, v196, s10, v40
    v_dot2_f32_bf16 v41, v196, s11, v41
    v_dot2_f32_bf16 v42, v197, s10, v42
    v_dot2_f32_bf16 v43, v197, s11, v43
    v_dot2_f32_bf16 v44, v198, s10, v44
    v_dot2_f32_bf16 v45, v198, s11, v45
    v_dot2_f32_bf16 v46, v199, s10, v46
    v_dot2_f32_bf16 v47, v199, s11, v47
    s_nop 2
    v_pk_mul_f32 v[48:49], v[32:33], v[32:33]
    v_pk_mul_f32 v[50:51], v[34:35], v[34:35]
    v_pk_mul_f32 v[52:53], v[36:37], v[36:37]
    v_pk_mul_f32 v[54:55], v[38:39], v[38:39]
    v_pk_mul_f32 v[56:57], v[40:41], v[40:41]
    v_pk_mul_f32 v[58:59], v[42:43], v[42:43]
    v_pk_mul_f32 v[60:61], v[44:45], v[44:45]
    v_pk_mul_f32 v[62:63], v[46:47], v[46:47]
    v_pk_fma_f32 v[48:49], v[48:49], v[24:25], v[26:27] op_sel_hi:[1,0,0]
    v_pk_fma_f32 v[50:51], v[50:51], v[24:25], v[26:27] op_sel_hi:[1,0,0]
    v_pk_fma_f32 v[52:53], v[52:53], v[24:25], v[26:27] op_sel_hi:[1,0,0]
    v_pk_fma_f32 v[54:55], v[54:55], v[24:25], v[26:27] op_sel_hi:[1,0,0]
    v_pk_fma_f32 v[56:57], v[56:57], v[24:25], v[26:27] op_sel_hi:[1,0,0]
    v_pk_fma_f32 v[58:59], v[58:59], v[24:25], v[26:27] op_sel_hi:[1,0,0]
    v_pk_fma_f32 v[60:61], v[60:61], v[24:25], v[26:27] op_sel_hi:[1,0,0]
    v_pk_fma_f32 v[62:63], v[62:63], v[24:25], v[26:27] op_sel_hi:[1,0,0]
    v_pk_mul_f32 v[48:49], v[48:49], v[32:33]
    v_pk_mul_f32 v[50:51], v[50:51], v[34:35]
    v_pk_mul_f32 v[52:53], v[52:53], v[36:37]
    v_pk_mul_f32 v[54:55], v[54:55], v[38:39]
    v_pk_mul_f32 v[56:57], v[56:57], v[40:41]
    v_pk_mul_f32 v[58:59], v[58:59], v[42:43]
    v_pk_mul_f32 v[60:61], v[60:61], v[44:45]
    v_pk_mul_f32 v[62:63], v[62:63], v[46:47]
    v_exp_f32 v48, v48
    v_exp_f32 v49, v49
    v_exp_f32 v50, v50
    v_exp_f32 v51, v51
    v_exp_f32 v52, v52
    v_exp_f32 v53, v53
    v_exp_f32 v54, v54
    v_exp_f32 v55, v55
    v_exp_f32 v56, v56
    v_exp_f32 v57, v57
    v_exp_f32 v58, v58
    v_exp_f32 v59, v59
    v_exp_f32 v60, v60
    v_exp_f32 v61, v61
    v_exp_f32 v62, v62
    v_exp_f32 v63, v63
    v_pk_add_f32 v[48:49], v[48:49], 1.0 op_sel_hi:[1,0]
    v_pk_add_f32 v[50:51], v[50:51], 1.0 op_sel_hi:[1,0]
    v_pk_add_f32 v[52:53], v[52:53], 1.0 op_sel_hi:[1,0]
    v_pk_add_f32 v[54:55], v[54:55], 1.0 op_sel_hi:[1,0]
    v_pk_add_f32 v[56:57], v[56:57], 1.0 op_sel_hi:[1,0]
    v_pk_add_f32 v[58:59], v[58:59], 1.0 op_sel_hi:[1,0]
    v_pk_add_f32 v[60:61], v[60:61], 1.0 op_sel_hi:[1,0]
    v_pk_add_f32 v[62:63], v[62:63], 1.0 op_sel_hi:[1,0]
    v_rcp_f32 v48, v48
    v_rcp_f32 v49, v49
    v_rcp_f32 v50, v50
    v_rcp_f32 v51, v51
    v_rcp_f32 v52, v52
    v_rcp_f32 v53, v53
    v_rcp_f32 v54, v54
    v_rcp_f32 v55, v55
    v_rcp_f32 v56, v56
    v_rcp_f32 v57, v57
    v_rcp_f32 v58, v58
    v_rcp_f32 v59, v59
    v_rcp_f32 v60, v60
    v_rcp_f32 v61, v61
    v_rcp_f32 v62, v62
    v_rcp_f32 v63, v63
    v_pk_mul_f32 v[48:49], v[48:49], v[32:33]
    v_pk_mul_f32 v[50:51], v[50:51], v[34:35]
    v_pk_mul_f32 v[52:53], v[52:53], v[36:37]
    v_pk_mul_f32 v[54:55], v[54:55], v[38:39]
    v_pk_mul_f32 v[56:57], v[56:57], v[40:41]
    v_pk_mul_f32 v[58:59], v[58:59], v[42:43]
    v_pk_mul_f32 v[60:61], v[60:61], v[44:45]
    v_pk_mul_f32 v[62:63], v[62:63], v[46:47]
    v_cvt_pk_bf16_f32 v64, v48, v49
    v_cvt_pk_bf16_f32 v65, v50, v51
    v_cvt_pk_bf16_f32 v66, v52, v53
    v_cvt_pk_bf16_f32 v67, v54, v55
    v_cvt_pk_bf16_f32 v68, v56, v57
    v_cvt_pk_bf16_f32 v69, v58, v59
    v_cvt_pk_bf16_f32 v70, v60, v61
    v_cvt_pk_bf16_f32 v71, v62, v63
    buffer_store_dwordx4 v[64:67], v23, s[84:87], s12 offen sc1
    buffer_store_dwordx4 v[68:71], v23, s[84:87], s12 offen offset:2048 sc1
    s_waitcnt lgkmcnt(0)
    s_add_u32 m0, s101, 0
    s_nop 0
    buffer_load_dwordx4 v10, s[68:71], s98 offen offset:0 lds
    buffer_load_dwordx4 v11, s[68:71], s98 offen offset:1024 lds
    buffer_load_dwordx4 v12, s[68:71], s98 offen offset:2048 lds
    buffer_load_dwordx4 v13, s[68:71], s98 offen offset:3072 lds
    s_add_u32 s98, s98, 131072
    s_cmp_eq_u32 s98, s89
    s_cselect_b32 s98, s88, s98
    s_add_u32 m0, s101, 4096
    s_nop 0
    buffer_load_dwordx4 v10, s[68:71], s98 offen offset:0 lds
    buffer_load_dwordx4 v11, s[68:71], s98 offen offset:1024 lds
    buffer_load_dwordx4 v12, s[68:71], s98 offen offset:2048 lds
    buffer_load_dwordx4 v13, s[68:71], s98 offen offset:3072 lds
    s_add_u32 s98, s98, 131072
    s_cmp_eq_u32 s98, s89
    s_cselect_b32 s98, s88, s98
    s_add_u32 m0, s101, 8192
    s_nop 0
    buffer_load_dwordx4 v10, s[68:71], s98 offen offset:0 lds
    buffer_load_dwordx4 v11, s[68:71], s98 offen offset:1024 lds
    buffer_load_dwordx4 v12, s[68:71], s98 offen offset:2048 lds
    buffer_load_dwordx4 v13, s[68:71], s98 offen offset:3072 lds
    s_add_u32 s98, s98, 131072
    s_cmp_eq_u32 s98, s89
    s_cselect_b32 s98, s88, s98
    s_add_u32 m0, s101, 12288
    s_nop 0
    buffer_load_dwordx4 v10, s[68:71], s98 offen offset:0 lds
    buffer_load_dwordx4 v11, s[68:71], s98 offen offset:1024 lds
    buffer_load_dwordx4 v12, s[68:71], s98 offen offset:2048 lds
    buffer_load_dwordx4 v13, s[68:71], s98 offen offset:3072 lds
    s_add_u32 s98, s98, 131072
    s_cmp_eq_u32 s98, s89
    s_cselect_b32 s98, s88, s98
    s_waitcnt vmcnt(16)
    s_cmp_eq_u32 s41, 0
    s_cbranch_scc1 L_nouf
    s_atomic_add s26, s[84:85], s9 offset:0
    s_atomic_add s26, s[84:85], s9 offset:1024
    s_atomic_add s26, s[84:85], s9 offset:2048
    s_atomic_add s26, s[84:85], s9 offset:3072
    s_atomic_add s26, s[84:85], s9 offset:4096
    s_atomic_add s26, s[84:85], s9 offset:5120
    s_atomic_add s26, s[84:85], s9 offset:6144
    s_atomic_add s26, s[84:85], s9 offset:7168
L_nouf:
    s_add_u32 m0, s101, 16384
    s_nop 0
    buffer_load_dwordx4 v10, s[68:71], s98 offen offset:0 lds
    buffer_load_dwordx4 v11, s[68:71], s98 offen offset:1024 lds
    buffer_load_dwordx4 v12, s[68:71], s98 offen offset:2048 lds
    buffer_load_dwordx4 v13, s[68:71], s98 offen offset:3072 lds
    s_add_u32 s98, s98, 131072
    s_cmp_eq_u32 s98, s89
    s_cselect_b32 s98, s88, s98
    s_waitcnt lgkmcnt(0)
    s_mul_i32 s90, s19, 229376
    s_mul_i32 s8, s92, 57344
    s_add_u32 s90, s90, s8
    s_add_u32 s90, s90, 2097152
    s_add_u32 s91, s90, 57344
    s_lshl_b32 s8, s17, 12
    s_add_u32 s99, s90, s8
    s_lshl_b32 s12, s19, 2
    s_add_u32 s12, s12, s92
    s_lshl_b32 s12, s12, 3
    s_add_u32 s12, s12, s4
    s_lshl_b32 s12, s12, 10
    s_add_u32 s12, s12, 6292224
    s_mov_b32 s14, 0
L_sp_85:
    s_load_dword s13, s[84:85], s12 offset:0 glc
    s_add_u32 s14, s14, 1
    s_waitcnt lgkmcnt(0)
    s_cmp_ge_u32 s13, 28
    s_cbranch_scc1 L_spd_86
    s_cmp_gt_u32 s14, 400000
    s_cbranch_scc0 L_sp_85
L_spd_86:
    buffer_load_dwordx4 v[176:179], v6, s[84:87], s99 offen offset:0 sc1
    buffer_load_dwordx4 v[180:183], v7, s[84:87], s99 offen offset:0 sc1
    buffer_load_dwordx4 v[184:187], v6, s[84:87], s99 offen offset:2048 sc1
    buffer_load_dwordx4 v[188:191], v7, s[84:87], s99 offen offset:2048 sc1
    s_add_u32 s99, s99, 4096
    s_cmp_eq_u32 s99, s91
    s_cselect_b32 s99, s90, s99
    buffer_load_dwordx4 v[192:195], v6, s[84:87], s99 offen offset:0 sc1
    buffer_load_dwordx4 v[196:199], v7, s[84:87], s99 offen offset:0 sc1
    buffer_load_dwordx4 v[200:203], v6, s[84:87], s99 offen offset:2048 sc1
    buffer_load_dwordx4 v[204:207], v7, s[84:87], s99 offen offset:2048 sc1
    s_add_u32 s99, s99, 4096
    s_cmp_eq_u32 s99, s91
    s_cselect_b32 s99, s90, s99
    buffer_load_dwordx4 v[208:211], v6, s[84:87], s99 offen offset:0 sc1
    buffer_load_dwordx4 v[212:215], v7, s[84:87], s99 offen offset:0 sc1
    buffer_load_dwordx4 v[216:219], v6, s[84:87], s99 offen offset:2048 sc1
    buffer_load_dwordx4 v[220:223], v7, s[84:87], s99 offen offset:2048 sc1
    s_add_u32 s99, s99, 4096
    s_cmp_eq_u32 s99, s91
    s_cselect_b32 s99, s90, s99
    buffer_load_dwordx4 v[224:227], v6, s[84:87], s99 offen offset:0 sc1
    buffer_load_dwordx4 v[228:231], v7, s[84:87], s99 offen offset:0 sc1
    buffer_load_dwordx4 v[232:235], v6, s[84:87], s99 offen offset:2048 sc1
    buffer_load_dwordx4 v[236:239], v7, s[84:87], s99 offen offset:2048 sc1
    s_add_u32 s99, s99, 4096
    s_cmp_eq_u32 s99, s91
    s_cselect_b32 s99, s90, s99
    s_setprio 0
    s_waitcnt lgkmcnt(0)
    s_waitcnt vmcnt(14)
    v_mfma_f32_32x32x16_bf16 v[32:47], v[176:179], v[96:99], 0
    v_mfma_f32_32x32x16_bf16 v[48:63], v[176:179], v[100:103], 0
    v_mfma_f32_32x32x16_bf16 v[80:95], v[180:183], v[100:103], 0
    v_mfma_f32_32x32x16_bf16 v[64:79], v[180:183], v[96:99], 0
    s_waitcnt vmcnt(12)
    v_mfma_f32_32x32x16_bf16 v[32:47], v[184:187], v[104:107], v[32:47]
    v_mfma_f32_32x32x16_bf16 v[48:63], v[184:187], v[108:111], v[48:63]
    v_mfma_f32_32x32x16_bf16 v[80:95], v[188:191], v[108:111], v[80:95]
    v_mfma_f32_32x32x16_bf16 v[64:79], v[188:191], v[104:107], v[64:79]
    buffer_load_dwordx4 v[176:179], v6, s[84:87], s99 offen offset:0 sc1
    buffer_load_dwordx4 v[180:183], v7, s[84:87], s99 offen offset:0 sc1
    buffer_load_dwordx4 v[184:187], v6, s[84:87], s99 offen offset:2048 sc1
    buffer_load_dwordx4 v[188:191], v7, s[84:87], s99 offen offset:2048 sc1
    s_add_u32 s99, s99, 4096
    s_cmp_eq_u32 s99, s91
    s_cselect_b32 s99, s90, s99
    s_waitcnt vmcnt(14)
    v_mfma_f32_32x32x16_bf16 v[32:47], v[192:195], v[112:115], v[32:47]
    v_mfma_f32_32x32x16_bf16 v[48:63], v[192:195], v[116:119], v[48:63]
    v_mfma_f32_32x32x16_bf16 v[80:95], v[196:199], v[116:119], v[80:95]
    v_mfma_f32_32x32x16_bf16 v[64:79], v[196:199], v[112:115], v[64:79]
    s_waitcnt vmcnt(12)
    v_mfma_f32_32x32x16_bf16 v[32:47], v[200:203], v[120:123], v[32:47]
    v_mfma_f32_32x32x16_bf16 v[48:63], v[200:203], v[124:127], v[48:63]
    v_mfma_f32_32x32x16_bf16 v[80:95], v[204:207], v[124:127], v[80:95]
    v_mfma_f32_32x32x16_bf16 v[64:79], v[204:207], v[120:123], v[64:79]
    buffer_load_dwordx4 v[192:195], v6, s[84:87], s99 offen offset:0 sc1
    buffer_load_dwordx4 v[196:199], v7, s[84:87], s99 offen offset:0 sc1
    buffer_load_dwordx4 v[200:203], v6, s[84:87], s99 offen offset:2048 sc1
    buffer_load_dwordx4 v[204:207], v7, s[84:87], s99 offen offset:2048 sc1
    s_add_u32 s99, s99, 4096
    s_cmp_eq_u32 s99, s91
    s_cselect_b32 s99, s90, s99
    s_waitcnt vmcnt(14)
    v_mfma_f32_32x32x16_bf16 v[32:47], v[208:211], v[128:131], v[32:47]
    v_mfma_f32_32x32x16_bf16 v[48:63], v[208:211], v[132:135], v[48:63]
    v_mfma_f32_32x32x16_bf16 v[80:95], v[212:215], v[132:135], v[80:95]
    v_mfma_f32_32x32x16_bf16 v[64:79], v[212:215], v[128:131], v[64:79]
    s_waitcnt vmcnt(12)
    v_mfma_f32_32x32x16_bf16 v[32:47], v[216:219], v[136:139], v[32:47]
    v_mfma_f32_32x32x16_bf16 v[48:63], v[216:219], v[140:143], v[48:63]
    v_mfma_f32_32x32x16_bf16 v[80:95], v[220:223], v[140:143], v[80:95]
    v_mfma_f32_32x32x16_bf16 v[64:79], v[220:223], v[136:139], v[64:79]
    buffer_load_dwordx4 v[208:211], v6, s[84:87], s99 offen offset:0 sc1
    buffer_load_dwordx4 v[212:215], v7, s[84:87], s99 offen offset:0 sc1
    buffer_load_dwordx4 v[216:219], v6, s[84:87], s99 offen offset:2048 sc1
    buffer_load_dwordx4 v[220:223], v7, s[84:87], s99 offen offset:2048 sc1
    s_add_u32 s99, s99, 4096
    s_cmp_eq_u32 s99, s91
    s_cselect_b32 s99, s90, s99
    s_waitcnt vmcnt(14)
    v_mfma_f32_32x32x16_bf16 v[32:47], v[224:227], v[144:147], v[32:47]
    v_mfma_f32_32x32x16_bf16 v[48:63], v[224:227], v[148:151], v[48:63]
    v_mfma_f32_32x32x16_bf16 v[80:95], v[228:231], v[148:151], v[80:95]
    v_mfma_f32_32x32x16_bf16 v[64:79], v[228:231], v[144:147], v[64:79]
    s_waitcnt vmcnt(12)
    v_mfma_f32_32x32x16_bf16 v[32:47], v[232:235], v[152:155], v[32:47]
    v_mfma_f32_32x32x16_bf16 v[48:63], v[232:235], v[156:159], v[48:63]
    v_mfma_f32_32x32x16_bf16 v[80:95], v[236:239], v[156:159], v[80:95]
    v_mfma_f32_32x32x16_bf16 v[64:79], v[236:239], v[152:155], v[64:79]
    buffer_load_dwordx4 v[224:227], v6, s[84:87], s99 offen offset:0 sc1
    buffer_load_dwordx4 v[228:231], v7, s[84:87], s99 offen offset:0 sc1
    buffer_load_dwordx4 v[232:235], v6, s[84:87], s99 offen offset:2048 sc1
    buffer_load_dwordx4 v[236:239], v7, s[84:87], s99 offen offset:2048 sc1
    s_add_u32 s99, s99, 4096
    s_cmp_eq_u32 s99, s91
    s_cselect_b32 s99, s90, s99
    s_waitcnt vmcnt(14)
    v_mfma_f32_32x32x16_bf16 v[32:47], v[176:179], v[160:163], v[32:47]
    v_mfma_f32_32x32x16_bf16 v[48:63], v[176:179], v[164:167], v[48:63]
    v_mfma_f32_32x32x16_bf16 v[80:95], v[180:183], v[164:167], v[80:95]
    v_mfma_f32_32x32x16_bf16 v[64:79], v[180:183], v[160:163], v[64:79]
    ds_read_b64_tr_b16 v[240:241], v4 offset:20480
    ds_read_b64_tr_b16 v[242:243], v4 offset:21504
    ds_read_b64_tr_b16 v[244:245], v5 offset:20480
    ds_read_b64_tr_b16 v[246:247], v5 offset:21504
    s_waitcnt vmcnt(12)
    v_mfma_f32_32x32x16_bf16 v[32:47], v[184:187], v[168:171], v[32:47]
    v_mfma_f32_32x32x16_bf16 v[48:63], v[184:187], v[172:175], v[48:63]
    v_mfma_f32_32x32x16_bf16 v[80:95], v[188:191], v[172:175], v[80:95]
    v_mfma_f32_32x32x16_bf16 v[64:79], v[188:191], v[168:171], v[64:79]
    buffer_load_dwordx4 v[176:179], v6, s[84:87], s99 offen offset:0 sc1
    buffer_load_dwordx4 v[180:183], v7, s[84:87], s99 offen offset:0 sc1
    buffer_load_dwordx4 v[184:187], v6, s[84:87], s99 offen offset:2048 sc1
    buffer_load_dwordx4 v[188:191], v7, s[84:87], s99 offen offset:2048 sc1
    s_add_u32 s99, s99, 4096
    s_cmp_eq_u32 s99, s91
    s_cselect_b32 s99, s90, s99
    ds_read_b64_tr_b16 v[248:249], v4 offset:22528
    ds_read_b64_tr_b16 v[250:251], v4 offset:23552
    ds_read_b64_tr_b16 v[252:253], v5 offset:22528
    ds_read_b64_tr_b16 v[254:255], v5 offset:23552
    s_waitcnt lgkmcnt(4)
    s_waitcnt vmcnt(14)
    v_mfma_f32_32x32x16_bf16 v[32:47], v[192:195], v[240:243], v[32:47]
    v_mfma_f32_32x32x16_bf16 v[48:63], v[192:195], v[244:247], v[48:63]
    v_mfma_f32_32x32x16_bf16 v[80:95], v[196:199], v[244:247], v[80:95]
    v_mfma_f32_32x32x16_bf16 v[64:79], v[196:199], v[240:243], v[64:79]
    ds_read_b64_tr_b16 v[240:241], v4 offset:0
    ds_read_b64_tr_b16 v[242:243], v4 offset:1024
    ds_read_b64_tr_b16 v[244:245], v5 offset:0
    ds_read_b64_tr_b16 v[246:247], v5 offset:1024
    s_waitcnt lgkmcnt(4)
    s_add_u32 m0, s101, 20480
    s_nop 0
    buffer_load_dwordx4 v10, s[68:71], s98 offen offset:0 lds
    buffer_load_dwordx4 v11, s[68:71], s98 offen offset:1024 lds
    buffer_load_dwordx4 v12, s[68:71], s98 offen offset:2048 lds
    buffer_load_dwordx4 v13, s[68:71], s98 offen offset:3072 lds
    s_add_u32 s98, s98, 131072
    s_cmp_eq_u32 s98, s89
    s_cselect_b32 s98, s88, s98
    s_waitcnt vmcnt(16)
    v_mfma_f32_32x32x16_bf16 v[32:47], v[200:203], v[248:251], v[32:47]
    v_mfma_f32_32x32x16_bf16 v[48:63], v[200:203], v[252:255], v[48:63]
    v_mfma_f32_32x32x16_bf16 v[80:95], v[204:207], v[252:255], v[80:95]
    v_mfma_f32_32x32x16_bf16 v[64:79], v[204:207], v[248:251], v[64:79]
    buffer_load_dwordx4 v[192:195], v6, s[84:87], s99 offen offset:0 sc1
    buffer_load_dwordx4 v[196:199], v7, s[84:87], s99 offen offset:0 sc1
    buffer_load_dwordx4 v[200:203], v6, s[84:87], s99 offen offset:2048 sc1
    buffer_load_dwordx4 v[204:207], v7, s[84:87], s99 offen offset:2048 sc1
    s_add_u32 s99, s99, 4096
    s_cmp_eq_u32 s99, s91
    s_cselect_b32 s99, s90, s99
    ds_read_b64_tr_b16 v[248:249], v4 offset:2048
    ds_read_b64_tr_b16 v[250:251], v4 offset:3072
    ds_read_b64_tr_b16 v[252:253], v5 offset:2048
    ds_read_b64_tr_b16 v[254:255], v5 offset:3072
    s_waitcnt lgkmcnt(4)
    s_waitcnt vmcnt(18)
    v_mfma_f32_32x32x16_bf16 v[32:47], v[208:211], v[240:243], v[32:47]
    v_mfma_f32_32x32x16_bf16 v[48:63], v[208:211], v[244:247], v[48:63]
    v_mfma_f32_32x32x16_bf16 v[80:95], v[212:215], v[244:247], v[80:95]
    v_mfma_f32_32x32x16_bf16 v[64:79], v[212:215], v[240:243], v[64:79]
    ds_read_b64_tr_b16 v[240:241], v4 offset:4096
    ds_read_b64_tr_b16 v[242:243], v4 offset:5120
    ds_read_b64_tr_b16 v[244:245], v5 offset:4096
    ds_read_b64_tr_b16 v[246:247], v5 offset:5120
    s_waitcnt lgkmcnt(4)
    s_add_u32 m0, s101, 0
    s_nop 0
    buffer_load_dwordx4 v10, s[68:71], s98 offen offset:0 lds
    buffer_load_dwordx4 v11, s[68:71], s98 offen offset:1024 lds
    buffer_load_dwordx4 v12, s[68:71], s98 offen offset:2048 lds
    buffer_load_dwordx4 v13, s[68:71], s98 offen offset:3072 lds
    s_add_u32 s98, s98, 131072
    s_cmp_eq_u32 s98, s89
    s_cselect_b32 s98, s88, s98
    s_waitcnt vmcnt(20)
    v_mfma_f32_32x32x16_bf16 v[32:47], v[216:219], v[248:251], v[32:47]
    v_mfma_f32_32x32x16_bf16 v[48:63], v[216:219], v[252:255], v[48:63]
    v_mfma_f32_32x32x16_bf16 v[80:95], v[220:223], v[252:255], v[80:95]
    v_mfma_f32_32x32x16_bf16 v[64:79], v[220:223], v[248:251], v[64:79]
    buffer_load_dwordx4 v[208:211], v6, s[84:87], s99 offen offset:0 sc1
    buffer_load_dwordx4 v[212:215], v7, s[84:87], s99 offen offset:0 sc1
    buffer_load_dwordx4 v[216:219], v6, s[84:87], s99 offen offset:2048 sc1
    buffer_load_dwordx4 v[220:223], v7, s[84:87], s99 offen offset:2048 sc1
    s_add_u32 s99, s99, 4096
    s_cmp_eq_u32 s99, s91
    s_cselect_b32 s99, s90, s99
    ds_read_b64_tr_b16 v[248:249], v4 offset:6144
    ds_read_b64_tr_b16 v[250:251], v4 offset:7168
    ds_read_b64_tr_b16 v[252:253], v5 offset:6144
    ds_read_b64_tr_b16 v[254:255], v5 offset:7168
    s_waitcnt lgkmcnt(4)
    s_waitcnt vmcnt(22)
    v_mfma_f32_32x32x16_bf16 v[32:47], v[224:227], v[240:243], v[32:47]
    v_mfma_f32_32x32x16_bf16 v[48:63], v[224:227], v[244:247], v[48:63]
    v_mfma_f32_32x32x16_bf16 v[80:95], v[228:231], v[244:247], v[80:95]
    v_mfma_f32_32x32x16_bf16 v[64:79], v[228:231], v[240:243], v[64:79]
    ds_read_b64_tr_b16 v[240:241], v4 offset:8192
    ds_read_b64_tr_b16 v[242:243], v4 offset:9216
    ds_read_b64_tr_b16 v[244:245], v5 offset:8192
    ds_read_b64_tr_b16 v[246:247], v5 offset:9216
    s_waitcnt lgkmcnt(4)
    s_lshl_b32 s8, s95, 6
    s_and_b32 s9, s92, 1
    s_lshl_b32 s9, s9, 5
    s_add_u32 s8, s8, s9
    v_and_b32 v24, 31, v1
    v_add_u32 v24, s8, v24
    v_lshlrev_b32 v25, 1, v24
    v_mul_u32_u24 v24, 896, v24
    s_lshl_b32 s8, s19, 7
    s_lshr_b32 s9, s92, 1
    s_lshl_b32 s9, s9, 6
    s_add_u32 s8, s8, s9
    v_add_u32 v24, s8, v24
    v_lshl_add_u32 v19, v18, 4, v24
    buffer_load_dwordx4 v[160:163], v19, s[44:47], 0 offen offset:0
    buffer_load_dwordx4 v[164:167], v19, s[44:47], 0 offen offset:32
    buffer_load_ushort v168, v25, s[72:75], 0 offen
    s_add_u32 m0, s101, 4096
    s_nop 0
    buffer_load_dwordx4 v10, s[68:71], s98 offen offset:0 lds
    buffer_load_dwordx4 v11, s[68:71], s98 offen offset:1024 lds
    buffer_load_dwordx4 v12, s[68:71], s98 offen offset:2048 lds
    buffer_load_dwordx4 v13, s[68:71], s98 offen offset:3072 lds
    s_add_u32 s98, s98, 131072
    s_cmp_eq_u32 s98, s89
    s_cselect_b32 s98, s88, s98
    s_waitcnt vmcnt(27)
    v_mfma_f32_32x32x16_bf16 v[32:47], v[232:235], v[248:251], v[32:47]
    v_mfma_f32_32x32x16_bf16 v[48:63], v[232:235], v[252:255], v[48:63]
    v_mfma_f32_32x32x16_bf16 v[80:95], v[236:239], v[252:255], v[80:95]
    v_mfma_f32_32x32x16_bf16 v[64:79], v[236:239], v[248:251], v[64:79]
    buffer_load_dwordx4 v[224:227], v6, s[84:87], s99 offen offset:0 sc1
    buffer_load_dwordx4 v[228:231], v7, s[84:87], s99 offen offset:0 sc1
    buffer_load_dwordx4 v[232:235], v6, s[84:87], s99 offen offset:2048 sc1
    buffer_load_dwordx4 v[236:239], v7, s[84:87], s99 offen offset:2048 sc1
    s_add_u32 s99, s99, 4096
    s_cmp_eq_u32 s99, s91
    s_cselect_b32 s99, s90, s99
    ds_read_b64_tr_b16 v[248:249], v4 offset:10240
    ds_read_b64_tr_b16 v[250:251], v4 offset:11264
    ds_read_b64_tr_b16 v[252:253], v5 offset:10240
    ds_read_b64_tr_b16 v[254:255], v5 offset:11264
    s_waitcnt lgkmcnt(4)
    s_waitcnt vmcnt(29)
    v_mfma_f32_32x32x16_bf16 v[32:47], v[176:179], v[240:243], v[32:47]
    v_mfma_f32_32x32x16_bf16 v[48:63], v[176:179], v[244:247], v[48:63]
    v_mfma_f32_32x32x16_bf16 v[80:95], v[180:183], v[244:247], v[80:95]
    v_mfma_f32_32x32x16_bf16 v[64:79], v[180:183], v[240:243], v[64:79]
    ds_read_b64_tr_b16 v[240:241], v4 offset:12288
    ds_read_b64_tr_b16 v[242:243], v4 offset:13312
    ds_read_b64_tr_b16 v[244:245], v5 offset:12288
    ds_read_b64_tr_b16 v[246:247], v5 offset:13312
    s_waitcnt lgkmcnt(4)
    v_mul_u32_u24 v10, 896, v14
    v_add_u32 v10, v10, v15
    v_add_u32 v11, 6144, v10
    v_add_u32 v12, 6144, v11
    v_add_u32 v13, 6144, v12
    s_mul_i32 s88, s92, 100352
    s_lshl_b32 s8, s19, 7
    s_add_u32 s88, s88, s8
    s_add_u32 s89, s88, 100352
    s_mul_i32 s8, s18, 25088
    s_add_u32 s98, s88, s8
    s_add_u32 m0, s101, 8192
    s_nop 0
    buffer_load_dwordx4 v10, s[56:59], s98 offen offset:0 lds
    buffer_load_dwordx4 v11, s[56:59], s98 offen offset:1024 lds
    buffer_load_dwordx4 v12, s[56:59], s98 offen offset:2048 lds
    buffer_load_dwordx4 v13, s[56:59], s98 offen offset:3072 lds
    s_add_u32 s98, s98, 25088
    s_cmp_eq_u32 s98, s89
    s_cselect_b32 s98, s88, s98
    s_waitcnt vmcnt(31)
    v_mfma_f32_32x32x16_bf16 v[32:47], v[184:187], v[248:251], v[32:47]
    v_mfma_f32_32x32x16_bf16 v[48:63], v[184:187], v[252:255], v[48:63]
    v_mfma_f32_32x32x16_bf16 v[80:95], v[188:191], v[252:255], v[80:95]
    v_mfma_f32_32x32x16_bf16 v[64:79], v[188:191], v[248:251], v[64:79]
    buffer_load_dwordx4 v[176:179], v6, s[84:87], s99 offen offset:0 sc1
    buffer_load_dwordx4 v[180:183], v7, s[84:87], s99 offen offset:0 sc1
    buffer_load_dwordx4 v[184:187], v6, s[84:87], s99 offen offset:2048 sc1
    buffer_load_dwordx4 v[188:191], v7, s[84:87], s99 offen offset:2048 sc1
    s_add_u32 s99, s99, 4096
    s_cmp_eq_u32 s99, s91
    s_cselect_b32 s99, s90, s99
    ds_read_b64_tr_b16 v[248:249], v4 offset:14336
    ds_read_b64_tr_b16 v[250:251], v4 offset:15360
    ds_read_b64_tr_b16 v[252:253], v5 offset:14336
    ds_read_b64_tr_b16 v[254:255], v5 offset:15360
    s_waitcnt lgkmcnt(4)
    s_waitcnt vmcnt(29)
    v_mfma_f32_32x32x16_bf16 v[32:47], v[192:195], v[240:243], v[32:47]
    v_mfma_f32_32x32x16_bf16 v[48:63], v[192:195], v[244:247], v[48:63]
    v_mfma_f32_32x32x16_bf16 v[80:95], v[196:199], v[244:247], v[80:95]
    v_mfma_f32_32x32x16_bf16 v[64:79], v[196:199], v[240:243], v[64:79]
    ds_read_b64_tr_b16 v[240:241], v4 offset:16384
    ds_read_b64_tr_b16 v[242:243], v4 offset:17408
    ds_read_b64_tr_b16 v[244:245], v5 offset:16384
    ds_read_b64_tr_b16 v[246:247], v5 offset:17408
    s_waitcnt lgkmcnt(4)
    s_add_u32 m0, s101, 12288
    s_nop 0
    buffer_load_dwordx4 v10, s[56:59], s98 offen offset:0 lds
    buffer_load_dwordx4 v11, s[56:59], s98 offen offset:1024 lds
    buffer_load_dwordx4 v12, s[56:59], s98 offen offset:2048 lds
    buffer_load_dwordx4 v13, s[56:59], s98 offen offset:3072 lds
    s_add_u32 s98, s98, 25088
    s_cmp_eq_u32 s98, s89
    s_cselect_b32 s98, s88, s98
    s_waitcnt vmcnt(31)
    v_mfma_f32_32x32x16_bf16 v[32:47], v[200:203], v[248:251], v[32:47]
    v_mfma_f32_32x32x16_bf16 v[48:63], v[200:203], v[252:255], v[48:63]
    v_mfma_f32_32x32x16_bf16 v[80:95], v[204:207], v[252:255], v[80:95]
    v_mfma_f32_32x32x16_bf16 v[64:79], v[204:207], v[248:251], v[64:79]
    buffer_load_dwordx4 v[192:195], v6, s[84:87], s99 offen offset:0 sc1
    buffer_load_dwordx4 v[196:199], v7, s[84:87], s99 offen offset:0 sc1
    buffer_load_dwordx4 v[200:203], v6, s[84:87], s99 offen offset:2048 sc1
    buffer_load_dwordx4 v[204:207], v7, s[84:87], s99 offen offset:2048 sc1
    s_add_u32 s99, s99, 4096
    s_cmp_eq_u32 s99, s91
    s_cselect_b32 s99, s90, s99
    ds_read_b64_tr_b16 v[248:249], v4 offset:18432
    ds_read_b64_tr_b16 v[250:251], v4 offset:19456
    ds_read_b64_tr_b16 v[252:253], v5 offset:18432
    ds_read_b64_tr_b16 v[254:255], v5 offset:19456
    s_waitcnt lgkmcnt(4)
    s_waitcnt vmcnt(29)
    v_mfma_f32_32x32x16_bf16 v[32:47], v[208:211], v[240:243], v[32:47]
    v_mfma_f32_32x32x16_bf16 v[48:63], v[208:211], v[244:247], v[48:63]
    v_mfma_f32_32x32x16_bf16 v[80:95], v[212:215], v[244:247], v[80:95]
    v_mfma_f32_32x32x16_bf16 v[64:79], v[212:215], v[240:243], v[64:79]
    ds_read_b64_tr_b16 v[240:241], v4 offset:20480
    ds_read_b64_tr_b16 v[242:243], v4 offset:21504
    ds_read_b64_tr_b16 v[244:245], v5 offset:20480
    ds_read_b64_tr_b16 v[246:247], v5 offset:21504
    s_waitcnt lgkmcnt(4)
    s_add_u32 m0, s101, 16384
    s_nop 0
    buffer_load_dwordx4 v10, s[56:59], s98 offen offset:0 lds
    buffer_load_dwordx4 v11, s[56:59], s98 offen offset:1024 lds
    buffer_load_dwordx4 v12, s[56:59], s98 offen offset:2048 lds
    buffer_load_dwordx4 v13, s[56:59], s98 offen offset:3072 lds
    s_add_u32 s98, s98, 25088
    s_cmp_eq_u32 s98, s89
    s_cselect_b32 s98, s88, s98
    s_waitcnt vmcnt(31)
    v_mfma_f32_32x32x16_bf16 v[32:47], v[216:219], v[248:251], v[32:47]
    v_mfma_f32_32x32x16_bf16 v[48:63], v[216:219], v[252:255], v[48:63]
    v_mfma_f32_32x32x16_bf16 v[80:95], v[220:223], v[252:255], v[80:95]
    v_mfma_f32_32x32x16_bf16 v[64:79], v[220:223], v[248:251], v[64:79]
    ds_read_b64_tr_b16 v[248:249], v4 offset:22528
    ds_read_b64_tr_b16 v[250:251], v4 offset:23552
    ds_read_b64_tr_b16 v[252:253], v5 offset:22528
    ds_read_b64_tr_b16 v[254:255], v5 offset:23552
    s_waitcnt lgkmcnt(4)
    s_waitcnt vmcnt(22)
    v_mfma_f32_32x32x16_bf16 v[32:47], v[224:227], v[240:243], v[32:47]
    v_mfma_f32_32x32x16_bf16 v[48:63], v[224:227], v[244:247], v[48:63]
    v_mfma_f32_32x32x16_bf16 v[80:95], v[228:231], v[244:247], v[80:95]
    v_mfma_f32_32x32x16_bf16 v[64:79], v[228:231], v[240:243], v[64:79]
    ds_read_b64_tr_b16 v[240:241], v4 offset:0
    ds_read_b64_tr_b16 v[242:243], v4 offset:1024
    ds_read_b64_tr_b16 v[244:245], v5 offset:0
    ds_read_b64_tr_b16 v[246:247], v5 offset:1024
    s_waitcnt lgkmcnt(4)
    s_add_u32 m0, s101, 20480
    s_nop 0
    buffer_load_dwordx4 v10, s[56:59], s98 offen offset:0 lds
    buffer_load_dwordx4 v11, s[56:59], s98 offen offset:1024 lds
    buffer_load_dwordx4 v12, s[56:59], s98 offen offset:2048 lds
    buffer_load_dwordx4 v13, s[56:59], s98 offen offset:3072 lds
    s_add_u32 s98, s98, 25088
    s_cmp_eq_u32 s98, s89
    s_cselect_b32 s98, s88, s98
    s_lshl_b32 s12, s95, 2
    s_add_u32 s12, s12, s92
    s_lshl_b32 s12, s12, 10
    s_add_u32 s12, s12, 6292352
    s_load_dword s11, s[84:85], s12 glc
    s_waitcnt vmcnt(24)
    v_mfma_f32_32x32x16_bf16 v[32:47], v[232:235], v[248:251], v[32:47]
    v_mfma_f32_32x32x16_bf16 v[48:63], v[232:235], v[252:255], v[48:63]
    v_mfma_f32_32x32x16_bf16 v[80:95], v[236:239], v[252:255], v[80:95]
    v_mfma_f32_32x32x16_bf16 v[64:79], v[236:239], v[248:251], v[64:79]
    ds_read_b64_tr_b16 v[248:249], v4 offset:2048
    ds_read_b64_tr_b16 v[250:251], v4 offset:3072
    ds_read_b64_tr_b16 v[252:253], v5 offset:2048
    ds_read_b64_tr_b16 v[254:255], v5 offset:3072
    s_waitcnt lgkmcnt(4)
    s_waitcnt vmcnt(18)
    v_mfma_f32_32x32x16_bf16 v[32:47], v[176:179], v[240:243], v[32:47]
    v_mfma_f32_32x32x16_bf16 v[48:63], v[176:179], v[244:247], v[48:63]
    v_mfma_f32_32x32x16_bf16 v[80:95], v[180:183], v[244:247], v[80:95]
    v_mfma_f32_32x32x16_bf16 v[64:79], v[180:183], v[240:243], v[64:79]
    ds_read_b64_tr_b16 v[240:241], v4 offset:4096
    ds_read_b64_tr_b16 v[242:243], v4 offset:5120
    ds_read_b64_tr_b16 v[244:245], v5 offset:4096
    ds_read_b64_tr_b16 v[246:247], v5 offset:5120
    s_waitcnt lgkmcnt(4)
    s_mul_i32 s90, s95, 65536
    s_mul_i32 s8, s92, 16384
    s_add_u32 s90, s90, s8
    s_add_u32 s90, s90, 4194304
    s_add_u32 s91, s90, 16384
    s_lshl_b32 s8, s18, 12
    s_add_u32 s99, s90, s8
    s_waitcnt lgkmcnt(0)
    s_cmp_ge_u32 s11, 8
    s_cselect_b64 vcc, -1, 0
    s_cbranch_scc0 L_olate
    buffer_load_dwordx4 v[96:99], v8, s[84:87], s99 offen offset:0 sc1
    buffer_load_dwordx4 v[100:103], v9, s[84:87], s99 offen offset:0 sc1
    buffer_load_dwordx4 v[104:107], v8, s[84:87], s99 offen offset:2048 sc1
    buffer_load_dwordx4 v[108:111], v9, s[84:87], s99 offen offset:2048 sc1
    s_add_u32 s99, s99, 4096
    s_cmp_eq_u32 s99, s91
    s_cselect_b32 s99, s90, s99
    buffer_load_dwordx4 v[112:115], v8, s[84:87], s99 offen offset:0 sc1
    buffer_load_dwordx4 v[116:119], v9, s[84:87], s99 offen offset:0 sc1
    buffer_load_dwordx4 v[120:123], v8, s[84:87], s99 offen offset:2048 sc1
    buffer_load_dwordx4 v[124:127], v9, s[84:87], s99 offen offset:2048 sc1
    s_add_u32 s99, s99, 4096
    s_cmp_eq_u32 s99, s91
    s_cselect_b32 s99, s90, s99
    buffer_load_dwordx4 v[128:131], v8, s[84:87], s99 offen offset:0 sc1
    buffer_load_dwordx4 v[132:135], v9, s[84:87], s99 offen offset:0 sc1
    buffer_load_dwordx4 v[136:139], v8, s[84:87], s99 offen offset:2048 sc1
    buffer_load_dwordx4 v[140:143], v9, s[84:87], s99 offen offset:2048 sc1
    s_add_u32 s99, s99, 4096
    s_cmp_eq_u32 s99, s91
    s_cselect_b32 s99, s90, s99
    buffer_load_dwordx4 v[144:147], v8, s[84:87], s99 offen offset:0 sc1
    buffer_load_dwordx4 v[148:151], v9, s[84:87], s99 offen offset:0 sc1
    buffer_load_dwordx4 v[152:155], v8, s[84:87], s99 offen offset:2048 sc1
    buffer_load_dwordx4 v[156:159], v9, s[84:87], s99 offen offset:2048 sc1
    s_add_u32 s99, s99, 4096
    s_cmp_eq_u32 s99, s91
    s_cselect_b32 s99, s90, s99
L_olate:
    s_waitcnt vmcnt(32)
    s_cbranch_vccnz L_cw_87
    s_waitcnt vmcnt(16)
L_cw_87:
    v_mfma_f32_32x32x16_bf16 v[32:47], v[184:187], v[248:251], v[32:47]
    v_mfma_f32_32x32x16_bf16 v[48:63], v[184:187], v[252:255], v[48:63]
    v_mfma_f32_32x32x16_bf16 v[80:95], v[188:191], v[252:255], v[80:95]
    v_mfma_f32_32x32x16_bf16 v[64:79], v[188:191], v[248:251], v[64:79]
    ds_read_b64_tr_b16 v[248:249], v4 offset:6144
    ds_read_b64_tr_b16 v[250:251], v4 offset:7168
    ds_read_b64_tr_b16 v[252:253], v5 offset:6144
    ds_read_b64_tr_b16 v[254:255], v5 offset:7168
    s_waitcnt lgkmcnt(4)
    s_waitcnt vmcnt(26)
    s_cbranch_vccnz L_cw_88
    s_waitcnt vmcnt(10)
L_cw_88:
    v_mfma_f32_32x32x16_bf16 v[32:47], v[192:195], v[240:243], v[32:47]
    v_mfma_f32_32x32x16_bf16 v[48:63], v[192:195], v[244:247], v[48:63]
    v_mfma_f32_32x32x16_bf16 v[80:95], v[196:199], v[244:247], v[80:95]
    v_mfma_f32_32x32x16_bf16 v[64:79], v[196:199], v[240:243], v[64:79]
    s_waitcnt lgkmcnt(0)
    s_waitcnt vmcnt(24)
    s_cbranch_vccnz L_cw_89
    s_waitcnt vmcnt(8)
L_cw_89:
    v_mfma_f32_32x32x16_bf16 v[32:47], v[200:203], v[248:251], v[32:47]
    v_mfma_f32_32x32x16_bf16 v[48:63], v[200:203], v[252:255], v[48:63]
    v_mfma_f32_32x32x16_bf16 v[80:95], v[204:207], v[252:255], v[80:95]
    v_mfma_f32_32x32x16_bf16 v[64:79], v[204:207], v[248:251], v[64:79]
    s_waitcnt vmcnt(16)
    s_cbranch_vccnz L_cw_90
    s_waitcnt vmcnt(0)
L_cw_90:
    s_cbranch_vccnz L_ohave
    s_mov_b32 s14, 0
L_sp_91:
    s_load_dword s13, s[84:85], s12 offset:0 glc
    s_add_u32 s14, s14, 1
    s_waitcnt lgkmcnt(0)
    s_cmp_ge_u32 s13, 8
    s_cbranch_scc1 L_spd_92
    s_cmp_gt_u32 s14, 400000
    s_cbranch_scc0 L_sp_91
L_spd_92:
    buffer_load_dwordx4 v[96:99], v8, s[84:87], s99 offen offset:0 sc1
    buffer_load_dwordx4 v[100:103], v9, s[84:87], s99 offen offset:0 sc1
    buffer_load_dwordx4 v[104:107], v8, s[84:87], s99 offen offset:2048 sc1
    buffer_load_dwordx4 v[108:111], v9, s[84:87], s99 offen offset:2048 sc1
    s_add_u32 s99, s99, 4096
    s_cmp_eq_u32 s99, s91
    s_cselect_b32 s99, s90, s99
    buffer_load_dwordx4 v[112:115], v8, s[84:87], s99 offen offset:0 sc1
    buffer_load_dwordx4 v[116:119], v9, s[84:87], s99 offen offset:0 sc1
    buffer_load_dwordx4 v[120:123], v8, s[84:87], s99 offen offset:2048 sc1
    buffer_load_dwordx4 v[124:127], v9, s[84:87], s99 offen offset:2048 sc1
    s_add_u32 s99, s99, 4096
    s_cmp_eq_u32 s99, s91
    s_cselect_b32 s99, s90, s99
    buffer_load_dwordx4 v[128:131], v8, s[84:87], s99 offen offset:0 sc1
    buffer_load_dwordx4 v[132:135], v9, s[84:87], s99 offen offset:0 sc1
    buffer_load_dwordx4 v[136:139], v8, s[84:87], s99 offen offset:2048 sc1
    buffer_load_dwordx4 v[140:143], v9, s[84:87], s99 offen offset:2048 sc1
    s_add_u32 s99, s99, 4096
    s_cmp_eq_u32 s99, s91
    s_cselect_b32 s99, s90, s99
    buffer_load_dwordx4 v[144:147], v8, s[84:87], s99 offen offset:0 sc1
    buffer_load_dwordx4 v[148:151], v9, s[84:87], s99 offen offset:0 sc1
    buffer_load_dwordx4 v[152:155], v8, s[84:87], s99 offen offset:2048 sc1
    buffer_load_dwordx4 v[156:159], v9, s[84:87], s99 offen offset:2048 sc1
    s_add_u32 s99, s99, 4096
    s_cmp_eq_u32 s99, s91
    s_cselect_b32 s99, s90, s99
L_ohave:
    ds_read_b64_tr_b16 v[240:241], v2 offset:8192
    ds_read_b64_tr_b16 v[242:243], v2 offset:9216
    ds_read_b64_tr_b16 v[244:245], v3 offset:8192
    ds_read_b64_tr_b16 v[246:247], v3 offset:9216
    ds_read_b64_tr_b16 v[248:249], v2 offset:10240
    ds_read_b64_tr_b16 v[250:251], v2 offset:11264
    ds_read_b64_tr_b16 v[252:253], v3 offset:10240
    ds_read_b64_tr_b16 v[254:255], v3 offset:11264
    s_waitcnt lgkmcnt(4)
    s_waitcnt vmcnt(14)
    v_mfma_f32_32x32x16_bf16 v[32:47], v[240:243], v[96:99], v[32:47]
    v_mfma_f32_32x32x16_bf16 v[48:63], v[240:243], v[100:103], v[48:63]
    v_mfma_f32_32x32x16_bf16 v[80:95], v[244:247], v[100:103], v[80:95]
    v_mfma_f32_32x32x16_bf16 v[64:79], v[244:247], v[96:99], v[64:79]
    ds_read_b64_tr_b16 v[240:241], v2 offset:12288
    ds_read_b64_tr_b16 v[242:243], v2 offset:13312
    ds_read_b64_tr_b16 v[244:245], v3 offset:12288
    ds_read_b64_tr_b16 v[246:247], v3 offset:13312
    s_waitcnt lgkmcnt(4)
    s_waitcnt vmcnt(12)
    v_mfma_f32_32x32x16_bf16 v[32:47], v[248:251], v[104:107], v[32:47]
    v_mfma_f32_32x32x16_bf16 v[48:63], v[248:251], v[108:111], v[48:63]
    v_mfma_f32_32x32x16_bf16 v[80:95], v[252:255], v[108:111], v[80:95]
    v_mfma_f32_32x32x16_bf16 v[64:79], v[252:255], v[104:107], v[64:79]
    ds_read_b64_tr_b16 v[248:249], v2 offset:14336
    ds_read_b64_tr_b16 v[250:251], v2 offset:15360
    ds_read_b64_tr_b16 v[252:253], v3 offset:14336
    ds_read_b64_tr_b16 v[254:255], v3 offset:15360
    s_waitcnt lgkmcnt(4)
    s_waitcnt vmcnt(10)
    v_mfma_f32_32x32x16_bf16 v[32:47], v[240:243], v[112:115], v[32:47]
    v_mfma_f32_32x32x16_bf16 v[48:63], v[240:243], v[116:119], v[48:63]
    v_mfma_f32_32x32x16_bf16 v[80:95], v[244:247], v[116:119], v[80:95]
    v_mfma_f32_32x32x16_bf16 v[64:79], v[244:247], v[112:115], v[64:79]
    ds_read_b64_tr_b16 v[240:241], v2 offset:16384
    ds_read_b64_tr_b16 v[242:243], v2 offset:17408
    ds_read_b64_tr_b16 v[244:245], v3 offset:16384
    ds_read_b64_tr_b16 v[246:247], v3 offset:17408
    s_waitcnt lgkmcnt(4)
    s_waitcnt vmcnt(8)
    v_mfma_f32_32x32x16_bf16 v[32:47], v[248:251], v[120:123], v[32:47]
    v_mfma_f32_32x32x16_bf16 v[48:63], v[248:251], v[124:127], v[48:63]
    v_mfma_f32_32x32x16_bf16 v[80:95], v[252:255], v[124:127], v[80:95]
    v_mfma_f32_32x32x16_bf16 v[64:79], v[252:255], v[120:123], v[64:79]
    ds_read_b64_tr_b16 v[248:249], v2 offset:18432
    ds_read_b64_tr_b16 v[250:251], v2 offset:19456
    ds_read_b64_tr_b16 v[252:253], v3 offset:18432
    ds_read_b64_tr_b16 v[254:255], v3 offset:19456
    s_waitcnt lgkmcnt(4)
    s_waitcnt vmcnt(6)
    v_mfma_f32_32x32x16_bf16 v[32:47], v[240:243], v[128:131], v[32:47]
    v_mfma_f32_32x32x16_bf16 v[48:63], v[240:243], v[132:135], v[48:63]
    v_mfma_f32_32x32x16_bf16 v[80:95], v[244:247], v[132:135], v[80:95]
    v_mfma_f32_32x32x16_bf16 v[64:79], v[244:247], v[128:131], v[64:79]
    ds_read_b64_tr_b16 v[240:241], v2 offset:20480
    ds_read_b64_tr_b16 v[242:243], v2 offset:21504
    ds_read_b64_tr_b16 v[244:245], v3 offset:20480
    ds_read_b64_tr_b16 v[246:247], v3 offset:21504
    s_waitcnt lgkmcnt(4)
    s_waitcnt vmcnt(4)
    v_mfma_f32_32x32x16_bf16 v[32:47], v[248:251], v[136:139], v[32:47]
    v_mfma_f32_32x32x16_bf16 v[48:63], v[248:251], v[140:143], v[48:63]
    v_mfma_f32_32x32x16_bf16 v[80:95], v[252:255], v[140:143], v[80:95]
    v_mfma_f32_32x32x16_bf16 v[64:79], v[252:255], v[136:139], v[64:79]
    ds_read_b64_tr_b16 v[248:249], v2 offset:22528
    ds_read_b64_tr_b16 v[250:251], v2 offset:23552
    ds_read_b64_tr_b16 v[252:253], v3 offset:22528
    ds_read_b64_tr_b16 v[254:255], v3 offset:23552
    s_waitcnt lgkmcnt(4)
    s_waitcnt vmcnt(2)
    v_mfma_f32_32x32x16_bf16 v[32:47], v[240:243], v[144:147], v[32:47]
    v_mfma_f32_32x32x16_bf16 v[48:63], v[240:243], v[148:151], v[48:63]
    v_mfma_f32_32x32x16_bf16 v[80:95], v[244:247], v[148:151], v[80:95]
    v_mfma_f32_32x32x16_bf16 v[64:79], v[244:247], v[144:147], v[64:79]
    s_waitcnt lgkmcnt(0)
    s_waitcnt vmcnt(0)
    v_mfma_f32_32x32x16_bf16 v[32:47], v[248:251], v[152:155], v[32:47]
    v_mfma_f32_32x32x16_bf16 v[48:63], v[248:251], v[156:159], v[48:63]
    v_mfma_f32_32x32x16_bf16 v[80:95], v[252:255], v[156:159], v[80:95]
    v_mfma_f32_32x32x16_bf16 v[64:79], v[252:255], v[152:155], v[64:79]
    v_add_u32 v24, s101, v23
    s_nop 10
    ds_write_b128 v24, v[48:51] offset:0
    ds_write_b128 v24, v[52:55] offset:1024
    ds_write_b128 v24, v[56:59] offset:2048
    ds_write_b128 v24, v[60:63] offset:3072
    ds_write_b128 v24, v[64:67] offset:4096
    ds_write_b128 v24, v[68:71] offset:5120
    ds_write_b128 v24, v[72:75] offset:6144
    ds_write_b128 v24, v[76:79] offset:7168
    ds_write_b128 v24, v[80:83] offset:8192
    ds_write_b128 v24, v[84:87] offset:9216
    ds_write_b128 v24, v[88:91] offset:10240
    ds_write_b128 v24, v[92:95] offset:11264
    s_mov_b64 exec, 1
    ds_add_u32 v20, v21 offset:8212
    s_mov_b64 exec, -1
    v_permlane32_swap_b32 v160, v162
    v_permlane32_swap_b32 v161, v163
    v_permlane32_swap_b32 v164, v166
    v_permlane32_swap_b32 v165, v167
    v_lshlrev_b32 v168, 16, v168
    s_mov_b32 s8, 0x00003f80
    s_mov_b32 s11, 0x3f800000
    v_pk_add_f32 v[32:33], v[32:33], v[168:169] op_sel_hi:[1,0]
    v_pk_add_f32 v[34:35], v[34:35], v[168:169] op_sel_hi:[1,0]
    v_pk_add_f32 v[36:37], v[36:37], v[168:169] op_sel_hi:[1,0]
    v_pk_add_f32 v[38:39], v[38:39], v[168:169] op_sel_hi:[1,0]
    v_pk_add_f32 v[40:41], v[40:41], v[168:169] op_sel_hi:[1,0]
    v_pk_add_f32 v[42:43], v[42:43], v[168:169] op_sel_hi:[1,0]
    v_pk_add_f32 v[44:45], v[44:45], v[168:169] op_sel_hi:[1,0]
    v_pk_add_f32 v[46:47], v[46:47], v[168:169] op_sel_hi:[1,0]
    v_dot2_f32_bf16 v32, v160, s8, v32
    v_dot2_f32_bf16 v33, v160, s11, v33
    v_dot2_f32_bf16 v34, v161, s8, v34
    v_dot2_f32_bf16 v35, v161, s11, v35
    v_dot2_f32_bf16 v36, v162, s8, v36
    v_dot2_f32_bf16 v37, v162, s11, v37
    v_dot2_f32_bf16 v38, v163, s8, v38
    v_dot2_f32_bf16 v39, v163, s11, v39
    v_dot2_f32_bf16 v40, v164, s8, v40
    v_dot2_f32_bf16 v41, v164, s11, v41
    v_dot2_f32_bf16 v42, v165, s8, v42
    v_dot2_f32_bf16 v43, v165, s11, v43
    v_dot2_f32_bf16 v44, v166, s8, v44
    v_dot2_f32_bf16 v45, v166, s11, v45
    v_dot2_f32_bf16 v46, v167, s8, v46
    v_dot2_f32_bf16 v47, v167, s11, v47
    s_xor_b32 s10, s92, 1
    s_mul_i32 s10, s10, 32768
    s_add_u32 s10, s10, 8704
    v_add_u32 v25, s10, v23
    s_xor_b32 s10, s92, 2
    s_mul_i32 s10, s10, 32768
    s_add_u32 s10, s10, 12800
    v_add_u32 v26, s10, v23
    s_xor_b32 s10, s92, 3
    s_mul_i32 s10, s10, 32768
    s_add_u32 s10, s10, 16896
    v_add_u32 v27, s10, v23
    s_mov_b32 s14, 0
L_ls_93:
    ds_read_b32 v22, v20 offset:8212
    s_add_u32 s14, s14, 1
    s_waitcnt lgkmcnt(0)
    v_readfirstlane_b32 s13, v22
    s_cmp_gt_u32 s14, 1600000
    s_cbranch_scc1 L_lsd_94
    s_cmp_ge_u32 s13, 4
    s_cbranch_scc1 L_lsd_94
    s_branch L_ls_93
L_lsd_94:
    ds_read_b128 v[48:51], v25 offset:0
    ds_read_b128 v[52:55], v25 offset:1024
    ds_read_b128 v[56:59], v25 offset:2048
    ds_read_b128 v[60:63], v25 offset:3072
    ds_read_b128 v[64:67], v26 offset:0
    ds_read_b128 v[68:71], v26 offset:1024
    ds_read_b128 v[72:75], v26 offset:2048
    ds_read_b128 v[76:79], v26 offset:3072
    ds_read_b128 v[80:83], v27 offset:0
    ds_read_b128 v[84:87], v27 offset:1024
    ds_read_b128 v[88:91], v27 offset:2048
    ds_read_b128 v[92:95], v27 offset:3072
    s_waitcnt lgkmcnt(8)
    v_pk_add_f32 v[32:33], v[32:33], v[48:49]
    v_pk_add_f32 v[34:35], v[34:35], v[50:51]
    v_pk_add_f32 v[36:37], v[36:37], v[52:53]
    v_pk_add_f32 v[38:39], v[38:39], v[54:55]
    v_pk_add_f32 v[40:41], v[40:41], v[56:57]
    v_pk_add_f32 v[42:43], v[42:43], v[58:59]
    v_pk_add_f32 v[44:45], v[44:45], v[60:61]
    v_pk_add_f32 v[46:47], v[46:47], v[62:63]
    s_waitcnt lgkmcnt(4)
    v_pk_add_f32 v[32:33], v[32:33], v[64:65]
    v_pk_add_f32 v[34:35], v[34:35], v[66:67]
    v_pk_add_f32 v[36:37], v[36:37], v[68:69]
    v_pk_add_f32 v[38:39], v[38:39], v[70:71]
    v_pk_add_f32 v[40:41], v[40:41], v[72:73]
    v_pk_add_f32 v[42:43], v[42:43], v[74:75]
    v_pk_add_f32 v[44:45], v[44:45], v[76:77]
    v_pk_add_f32 v[46:47], v[46:47], v[78:79]
    s_waitcnt lgkmcnt(0)
    v_pk_add_f32 v[32:33], v[32:33], v[80:81]
    v_pk_add_f32 v[34:35], v[34:35], v[82:83]
    v_pk_add_f32 v[36:37], v[36:37], v[84:85]
    v_pk_add_f32 v[38:39], v[38:39], v[86:87]
    v_pk_add_f32 v[40:41], v[40:41], v[88:89]
    v_pk_add_f32 v[42:43], v[42:43], v[90:91]
    v_pk_add_f32 v[44:45], v[44:45], v[92:93]
    v_pk_add_f32 v[46:47], v[46:47], v[94:95]
    v_cvt_pk_bf16_f32 v48, v32, v33
    v_cvt_pk_bf16_f32 v49, v34, v35
    v_cvt_pk_bf16_f32 v50, v36, v37
    v_cvt_pk_bf16_f32 v51, v38, v39
    v_cvt_pk_bf16_f32 v52, v40, v41
    v_cvt_pk_bf16_f32 v53, v42, v43
    v_cvt_pk_bf16_f32 v54, v44, v45
    v_cvt_pk_bf16_f32 v55, v46, v47
    s_nop 1
    v_permlane32_swap_b32 v48, v50
    v_permlane32_swap_b32 v49, v51
    v_permlane32_swap_b32 v52, v54
    v_permlane32_swap_b32 v53, v55
    s_nop 1
    buffer_store_dwordx4 v[48:51], v19, s[76:79], 0 offen
    buffer_store_dwordx4 v[52:55], v19, s[76:79], 0 offen offset:32
    s_branch L_end
L_idle1:
    s_mov_b32 s14, 0
L_ls_95:
    ds_read_b32 v22, v20 offset:8216
    s_add_u32 s14, s14, 1
    s_waitcnt lgkmcnt(0)
    v_readfirstlane_b32 s13, v22
    s_cmp_gt_u32 s14, 1600000
    s_cbranch_scc1 L_lsd_96
    s_cmp_ge_u32 s13, 4
    s_cbranch_scc1 L_lsd_96
    s_sleep 1
    s_branch L_ls_95
L_lsd_96:
    s_mov_b32 s14, 0
L_ls_97:
    ds_read_b32 v22, v20 offset:8264
    s_add_u32 s14, s14, 1
    s_waitcnt lgkmcnt(0)
    v_readfirstlane_b32 s13, v22
    s_cmp_gt_u32 s14, 1600000
    s_cbranch_scc1 L_lsd_98
    s_cmp_ge_u32 s13, 4
    s_cbranch_scc1 L_lsd_98
    s_sleep 1
    s_branch L_ls_97
L_lsd_98:
    s_mov_b64 exec, 1
    ds_add_u32 v20, v21 offset:8228
    s_mov_b64 exec, -1
    s_branch L_end
L_end:
L_exit:
    s_endpgm
L_code_end:
    .p2align 6
    .type L_table,@object
L_table:
    .long 0x00020100, 0x000001e4
    .long 0x00020907, 0x000021e4
    .long 0x00021100, 0x000043b1
    .long 0x00021907, 0x000063b1
    .long 0x00022100, 0x0000854e
    .long 0x00022907, 0x0000a54e
    .long 0x00023100, 0x0000c71b
    .long 0x00023907, 0x0000e71b
    .long 0x048a4120, 0x000001e4
    .long 0x048a4927, 0x000021e4
    .long 0x048a5120, 0x000043b1
    .long 0x048a5927, 0x000063b1
    .long 0x048a6120, 0x0000854e
    .long 0x048a6927, 0x0000a54e
    .long 0x048a7120, 0x0000c71b
    .long 0x048a7927, 0x0000e71b
    .long 0x09128140, 0x000001e4
    .long 0x09128947, 0x000021e4
    .long 0x09129140, 0x000043e1
    .long 0x09129947, 0x000063e1
    .long 0x0912a140, 0x000085d2
    .long 0x0912a947, 0x0000a5d2
    .long 0x0912b140, 0x0000c6e4
    .long 0x0912b947, 0x0000e6e4
    .long 0x0d9ac160, 0x000001e4
    .long 0x0d9ac967, 0x000021e4
    .long 0x0d9ad160, 0x000043e1
    .long 0x0d9ad967, 0x000063e1
    .long 0x0d9ae160, 0x000085d2
    .long 0x0d9ae967, 0x0000a5d2
    .long 0x0d9af160, 0x0000c6e4
    .long 0x0d9af967, 0x0000e6e4
    .long 0x02070101, 0x000001e4
    .long 0x02070908, 0x000021e4
    .long 0x02071101, 0x000043b1
    .long 0x02071908, 0x000063b1
    .long 0x02072101, 0x0000854e
    .long 0x02072908, 0x0000a54e
    .long 0x02073101, 0x0000c71b
    .long 0x02073908, 0x0000e71b
    .long 0x068f4121, 0x000001e4
    .long 0x068f4928, 0x000021e4
    .long 0x068f5121, 0x000043b1
    .long 0x068f5928, 0x000063b1
    .long 0x068f6121, 0x0000854e
    .long 0x068f6928, 0x0000a54e
    .long 0x068f7121, 0x0000c71b
    .long 0x068f7928, 0x0000e71b
    .long 0x0b178141, 0x000001e4
    .long 0x0b178948, 0x000021e4
    .long 0x0b179141, 0x000043e1
    .long 0x0b179948, 0x000063e1
    .long 0x0b17a141, 0x000085d2
    .long 0x0b17a948, 0x0000a5d2
    .long 0x0b17b141, 0x0000c6e4
    .long 0x0b17b948, 0x0000e6e4
    .long 0x04de0361, 0x000001e4
    .long 0x04de0b68, 0x000021e4
    .long 0x04de1361, 0x000043e1
    .long 0x04de1b68, 0x000063e1
    .long 0x04de2361, 0x000085d2
    .long 0x04de2b68, 0x0000a5d2
    .long 0x04de3361, 0x0000c6e4
    .long 0x04de3b68, 0x0000e6e4
    .long 0x094a4302, 0x000001e4
    .long 0x094a4b09, 0x000021e4
    .long 0x094a5302, 0x000043b1
    .long 0x094a5b09, 0x000063b1
    .long 0x094a6302, 0x0000854e
    .long 0x094a6b09, 0x0000a54e
    .long 0x094a7302, 0x0000c71b
    .long 0x094a7b09, 0x0000e71b
    .long 0x0dd28322, 0x000001e4
    .long 0x0dd28b29, 0x000021e4
    .long 0x0dd29322, 0x000043b1
    .long 0x0dd29b29, 0x000063b1
    .long 0x0dd2a322, 0x0000854e
    .long 0x0dd2ab29, 0x0000a54e
    .long 0x0dd2b322, 0x0000c71b
    .long 0x0dd2bb29, 0x0000e71b
    .long 0x025ac342, 0x000001e4
    .long 0x025acb49, 0x000021e4
    .long 0x025ad342, 0x000043e1
    .long 0x025adb49, 0x000063e1
    .long 0x025ae342, 0x000085d2
    .long 0x025aeb49, 0x0000a5d2
    .long 0x025af342, 0x0000c6e4
    .long 0x025afb49, 0x0000e6e4
    .long 0x06c30362, 0x000001e4
    .long 0x06c30b69, 0x000021e4
    .long 0x06c31362, 0x000043e1
    .long 0x06c31b69, 0x000063e1
    .long 0x06c32362, 0x000085d2
    .long 0x06c32b69, 0x0000a5d2
    .long 0x06c33362, 0x0000c6e4
    .long 0x06c33b69, 0x0000e6e4
    .long 0x0b4f4303, 0x000001e4
    .long 0x0b4f4b0a, 0x000021e4
    .long 0x0b4f5303, 0x000043b1
    .long 0x0b4f5b0a, 0x000063b1
    .long 0x0b4f6303, 0x0000854e
    .long 0x0b4f6b0a, 0x0000a54e
    .long 0x0b4f7303, 0x0000c71b
    .long 0x0b4f7b0a, 0x0000e71b
    .long 0x0c578323, 0x000001e4
    .long 0x0c578b2a, 0x000021e4
    .long 0x0c579323, 0x000043b1
    .long 0x0c579b2a, 0x000063b1
    .long 0x0c57a323, 0x0000854e
    .long 0x0c57ab2a, 0x0000a54e
    .long 0x0c57b323, 0x0000c71b
    .long 0x0c57bb2a, 0x0000e71b
    .long 0x09de0543, 0x000001e4
    .long 0x09de0d4a, 0x000021e4
    .long 0x09de1543, 0x000043e1
    .long 0x09de1d4a, 0x000063e1
    .long 0x09de2543, 0x000085d2
    .long 0x09de2d4a, 0x0000a5d2
    .long 0x09de3543, 0x0000c6e4
    .long 0x09de3d4a, 0x0000e6e4
    .long 0x0e464563, 0x000001e4
    .long 0x0e464d6a, 0x000021e4
    .long 0x0e465563, 0x000043e1
    .long 0x0e465d6a, 0x000063e1
    .long 0x0e466563, 0x000085d2
    .long 0x0e466d6a, 0x0000a5d2
    .long 0x0e467563, 0x0000c6e4
    .long 0x0e467d6a, 0x0000e6e4
    .long 0x02d28504, 0x000001e4
    .long 0x02d28d0b, 0x000021e4
    .long 0x02d29504, 0x000043b1
    .long 0x02d29d0b, 0x000063b1
    .long 0x02d2a504, 0x0000854e
    .long 0x02d2ad0b, 0x0000a54e
    .long 0x02d2b504, 0x0000c71b
    .long 0x02d2bd0b, 0x0000e71b
    .long 0x075ac524, 0x000001e4
    .long 0x075acd2b, 0x000021e4
    .long 0x075ad524, 0x000043b1
    .long 0x075add2b, 0x000063b1
    .long 0x075ae524, 0x0000854e
    .long 0x075aed2b, 0x0000a54e
    .long 0x075af524, 0x0000c71b
    .long 0x075afd2b, 0x0000e71b
    .long 0x08430544, 0x000001e4
    .long 0x08430d4b, 0x000021e4
    .long 0x08431544, 0x000043e1
    .long 0x08431d4b, 0x000063e1
    .long 0x08432544, 0x000085d2
    .long 0x08432d4b, 0x0000a5d2
    .long 0x08433544, 0x0000c6e4
    .long 0x08433d4b, 0x0000e6e4
    .long 0x0ccb4564, 0x000001e4
    .long 0x0ccb4d6b, 0x000021e4
    .long 0x0ccb5564, 0x000043e1
    .long 0x0ccb5d6b, 0x000063e1
    .long 0x0ccb6564, 0x000085d2
    .long 0x0ccb6d6b, 0x0000a5d2
    .long 0x0ccb7564, 0x0000c6e4
    .long 0x0ccb7d6b, 0x0000e6e4
    .long 0x01578505, 0x000001e4
    .long 0x01578d0c, 0x000021e4
    .long 0x01579505, 0x000043b1
    .long 0x01579d0c, 0x000063b1
    .long 0x0157a505, 0x0000854e
    .long 0x0157ad0c, 0x0000a54e
    .long 0x0157b505, 0x0000c71b
    .long 0x0157bd0c, 0x0000e71b
    .long 0x0e9e0725, 0x000001e4
    .long 0x0e9e0f2c, 0x000021e4
    .long 0x0e9e1725, 0x000043b1
    .long 0x0e9e1f2c, 0x000063b1
    .long 0x0e9e2725, 0x0000854e
    .long 0x0e9e2f2c, 0x0000a54e
    .long 0x0e9e3725, 0x0000c71b
    .long 0x0e9e3f2c, 0x0000e71b
    .long 0x03064745, 0x000001e4
    .long 0x03064f4c, 0x000021e4
    .long 0x03065745, 0x000043e1
    .long 0x03065f4c, 0x000063e1
    .long 0x03066745, 0x000085d2
    .long 0x03066f4c, 0x0000a5d2
    .long 0x03067745, 0x0000c6e4
    .long 0x03067f4c, 0x0000e6e4
    .long 0x040e8765, 0x000001e4
    .long 0x040e8f6c, 0x000021e4
    .long 0x040e9765, 0x000043e1
    .long 0x040e9f6c, 0x000063e1
    .long 0x040ea765, 0x000085d2
    .long 0x040eaf6c, 0x0000a5d2
    .long 0x040eb765, 0x0000c6e4
    .long 0x040ebf6c, 0x0000e6e4
    .long 0x089ac706, 0x000001e4
    .long 0x089acf0d, 0x000021e4
    .long 0x089ad706, 0x000043b1
    .long 0x089adf0d, 0x000063b1
    .long 0x089ae706, 0x0000854e
    .long 0x089aef0d, 0x0000a54e
    .long 0x089af706, 0x0000c71b
    .long 0x089aff0d, 0x0000e71b
    .long 0x0d030726, 0x000001e4
    .long 0x0d030f2d, 0x000021e4
    .long 0x0d031726, 0x000043b1
    .long 0x0d031f2d, 0x000063b1
    .long 0x0d032726, 0x0000854e
    .long 0x0d032f2d, 0x0000a54e
    .long 0x0d033726, 0x0000c71b
    .long 0x0d033f2d, 0x0000e71b
    .long 0x018b4746, 0x000001e4
    .long 0x018b4f4d, 0x000021e4
    .long 0x018b5746, 0x000043e1
    .long 0x018b5f4d, 0x000063e1
    .long 0x018b6746, 0x000085d2
    .long 0x018b6f4d, 0x0000a5d2
    .long 0x018b7746, 0x0000c6e4
    .long 0x018b7f4d, 0x0000e6e4
    .long 0x06138766, 0x000001e4
    .long 0x06138f6d, 0x000021e4
    .long 0x06139766, 0x000043e1
    .long 0x06139f6d, 0x000063e1
    .long 0x0613a766, 0x000085d2
    .long 0x0613af6d, 0x0000a5d2
    .long 0x0613b766, 0x0000c6e4
    .long 0x0613bf6d, 0x0000e6e4
    .long 0x00000000, 0x00000000
    .long 0x00000000, 0x00002000
    .long 0x00000000, 0x00004200
    .long 0x00000000, 0x00006200
    .long 0x00000000, 0x00008400
    .long 0x00000000, 0x0000a400
    .long 0x00000000, 0x0000c600
    .long 0x00000000, 0x0000e600
    .long 0x00000000, 0x00000000
    .long 0x00000000, 0x00002000
    .long 0x00000000, 0x00004200
    .long 0x00000000, 0x00006200
    .long 0x00000000, 0x00008400
    .long 0x00000000, 0x0000a400
    .long 0x00000000, 0x0000c600
    .long 0x00000000, 0x0000e600
    .long 0x00000000, 0x00000000
    .long 0x00000000, 0x00002000
    .long 0x00000000, 0x00004200
    .long 0x00000000, 0x00006200
    .long 0x00000000, 0x00008400
    .long 0x00000000, 0x0000a400
    .long 0x00000000, 0x0000c600
    .long 0x00000000, 0x0000e600
    .long 0x00000000, 0x00000000
    .long 0x00000000, 0x00002000
    .long 0x00000000, 0x00004200
    .long 0x00000000, 0x00006200
    .long 0x00000000, 0x00008400
    .long 0x00000000, 0x0000a400
    .long 0x00000000, 0x0000c600
    .long 0x00000000, 0x0000e600
.section .rodata,"a"
.p2align 6
.amdhsa_kernel parallel_sum__grouped_kv_mqa__mixer_token_mlp__prompt_kernel
  .amdhsa_next_free_vgpr 256
  .amdhsa_next_free_sgpr 102
  .amdhsa_accum_offset 256
  .amdhsa_group_segment_fixed_size 0
  .amdhsa_kernarg_size 104
  .amdhsa_user_sgpr_count 2
  .amdhsa_user_sgpr_kernarg_segment_ptr 1
  .amdhsa_system_sgpr_workgroup_id_x 1
.end_amdhsa_kernel
```
